```python
import torch

def _softmax(x, axis=-1):
    return torch.softmax(x, dim=axis)
def _gelu(x):
    return torch.nn.functional.gelu(x, approximate="tanh")
def _silu(x):
    return torch.nn.functional.silu(x)
def _sigmoid(x):
    return torch.sigmoid(x)
def _layernorm(x, axis=-1, eps=1e-5):
    m = x.mean(dim=axis, keepdim=True)
    v = x.var(dim=axis, keepdim=True, unbiased=False)
    return (x - m) / torch.sqrt(v + eps)
def _scatter_add(tgt, idx, src, axis=0):
    return tgt.clone().index_add_(axis, idx, src)
def _segment_sum(src, seg, n):
    out = torch.zeros((n,) + src.shape[1:], dtype=src.dtype)
    return out.index_add_(0, seg, src)
def _pad(x, pw):
    flat = tuple(v for pair in reversed(pw) for v in pair)
    return torch.nn.functional.pad(x, flat)

kernel_name = 'sequential_preLN__sliding_block_cached__mixer_token_mlp__decode'

def setup_inputs():

    _w = (lambda a: (lambda t: t.to(torch.bfloat16) if t.is_floating_point() else t)(torch.as_tensor(a)))
    def _A_setup():
        B, Sq, D = 4, 1, 448
        Hq, Hkv, Sk, Dh = 16, 8, 8192, 256
        assert Hq % Hkv == 0, (Hq, Hkv)
        return {
            "x": _w((lambda *s: torch.randn(*s, dtype=torch.bfloat16) * 0.05)(B, Sq, D)),
            "k_cache": _w((lambda *s: torch.randn(*s, dtype=torch.bfloat16) * 1.6)(B, Hkv, Sk, Dh)),
            "v_cache": _w((lambda *s: torch.randn(*s, dtype=torch.bfloat16) * 0.4)(B, Hkv, Sk, Dh)),
            "wq": _w((lambda *s: torch.randn(*s, dtype=torch.bfloat16) * 1.6)(D, Hq * Dh) * (D ** -0.5)),
            "wo": _w((lambda *s: torch.randn(*s, dtype=torch.bfloat16) * 0.4)(Hq * Dh, D) * ((Hq * Dh) ** -0.5)),
        }
    _A_in = _A_setup()

    def _B_setup():
        B, S, D, F = 4, 1, 448, 1792
        return {
            "x": _w((lambda *s: torch.randn(*s, dtype=torch.bfloat16) * 0.05)(B, S, D)),
            "w1": _w((lambda *s: torch.randn(*s, dtype=torch.bfloat16) * 1.6)(S, F) * (S ** -0.5)),
            "b1": _w((lambda *s: torch.randn(*s, dtype=torch.bfloat16) * 1.6)(F) * 0.02),
            "w2": _w((lambda *s: torch.randn(*s, dtype=torch.bfloat16) * 0.1)(F, S) * (F ** -0.5)),
            "b2": _w((lambda *s: torch.randn(*s, dtype=torch.bfloat16) * 0.1)(S) * 0.02),
        }
    _B_in = _B_setup()

    return {
        "A_x": _A_in["x"],
        "A_k_cache": _A_in["k_cache"],
        "A_v_cache": _A_in["v_cache"],
        "A_wq": _A_in["wq"],
        "A_wo": _A_in["wo"],
        "B_x": _B_in["x"],
        "B_w1": _B_in["w1"],
        "B_b1": _B_in["b1"],
        "B_w2": _B_in["w2"],
        "B_b2": _B_in["b2"],
    }

def reference(A_x, A_k_cache, A_v_cache, A_wq, A_wo, B_x, B_w1, B_b1, B_w2, B_b2):
    def _A_ref(x, k_cache, v_cache, wq, wo):
        B, Sq, D = x.shape
        Hq, Dh = 16, 256
        Hkv, Sk = k_cache.shape[1], k_cache.shape[2]
        W = min(4096, max(256, Sk // 4))
        rep = Hq // Hkv
        q = (lambda x, *d: x.permute(*d))((x @ wq).reshape(B, Sq, Hq, Dh), 0, 2, 1, 3)
        k = (lambda x, n, axis: torch.repeat_interleave(x, n, dim=axis))(k_cache[:, :, Sk - W:, :], rep, axis=1)
        v = (lambda x, n, axis: torch.repeat_interleave(x, n, dim=axis))(v_cache[:, :, Sk - W:, :], rep, axis=1)
        scores = torch.einsum("bhqd,bhkd->bhqk", q, k) * (Dh ** -0.5)
        p = _softmax(scores, axis=-1)
        o = torch.einsum("bhqk,bhkd->bhqd", p, v)
        return (lambda x, *d: x.permute(*d))(o, 0, 2, 1, 3).reshape(B, Sq, Hq * Dh) @ wo

    def _B_ref(x, w1, b1, w2, b2):
        B, S, D = x.shape
        h = _layernorm(x, axis=-1)
        u = torch.einsum("bsd,sf->bdf", h, w1) + b1
        u = _gelu(u)
        y = torch.einsum("bdf,fs->bds", u, w2) + b2
        return (lambda x, *d: x.permute(*d))(y, 0, 2, 1)

    x = A_x
    h = x + _A_ref(_layernorm(x, axis=-1), A_k_cache, A_v_cache, A_wq, A_wo)
    h2 = h + _B_ref(_layernorm(h, axis=-1), B_w1, B_b1, B_w2, B_b2)
    return h2
```

```asm
; @launch grid=(256,1,1) block=(576,1,1) lds=163840
.amdgcn_target "amdgcn-amd-amdhsa--gfx950"
.text
.globl sequential_preLN__sliding_block_cached__mixer_token_mlp__decode_kernel
.p2align 8
.type sequential_preLN__sliding_block_cached__mixer_token_mlp__decode_kernel,@function
sequential_preLN__sliding_block_cached__mixer_token_mlp__decode_kernel:
    s_cmpk_ge_u32 s2, 256
    s_cbranch_scc1 L_end
    s_load_dwordx16 s[4:19], s[0:1], 0
    v_lshrrev_b32 v1, 6, v0
    s_lshr_b32 s31, s2, 3
    v_readfirstlane_b32 s3, v1
    s_getpc_b64 s[40:41]
L_pc0:
    v_lshlrev_b32 v8, 4, v0
    s_add_u32 s42, s3, s31
    s_and_b32 s42, s42, 7
    s_cbranch_scc1 L_nopf0
    v_mov_b32 v9, s41
    v_add_co_u32 v8, vcc, s40, v8
    v_addc_co_u32 v9, vcc, 0, v9, vcc
    global_load_dwordx4 v[20:23], v[8:9], off
L_nopf0:
    s_and_b32 s30, s2, 7
    s_and_b32 s32, s31, 3
    s_lshr_b32 s33, s31, 2
    s_lshl3_add_u32 s35, s32, s30
    s_cmp_eq_u32 s3, 0
    s_cbranch_scc1 L_loader
    s_barrier
    s_branch L_compute
L_loader:
    s_mov_b32 s46, 917504
    s_mul_i32 s40, s32, s46
    s_lshl3_add_u32 s41, s30, s33
    s_lshl_b32 s41, s41, 7
    s_add_u32 s40, s40, s41
    s_mov_b32 s43, 64512
    v_lshrrev_b32 v12, 3, v0
    v_lshlrev_b32 v12, 13, v12
    v_and_b32 v13, 7, v0
    v_lshrrev_b32 v14, 4, v0
    v_lshlrev_b32 v14, 1, v14
    v_xor_b32 v13, v13, v14
    v_lshl_or_b32 v12, v13, 4, v12
    v_add_u32 v13, s43, v12
    v_add_u32 v14, s43, v13
    v_add_u32 v15, s43, v14
    s_mov_b32 s47, 0x20000
    s_mov_b32 m0, s47
    s_lshl_b32 s42, s47, 1
    s_mov_b32 s41, 0
    s_waitcnt lgkmcnt(0)
    s_add_u32 s44, s10, s40
    s_addc_u32 s45, s11, 0
L_wq:
    buffer_load_dwordx4 v12, s[44:47], s41 offen offset:0 nt lds
    buffer_load_dwordx4 v13, s[44:47], s41 offen offset:1024 nt lds
    buffer_load_dwordx4 v14, s[44:47], s41 offen offset:2048 nt lds
    buffer_load_dwordx4 v15, s[44:47], s41 offen offset:3072 nt lds
    s_addk_i32 m0, 4096
    s_add_u32 s41, s41, s42
    s_bitcmp0_b32 s41, 20
    s_cbranch_scc1 L_wq
    s_setprio 3
    s_mov_b32 s60, 0x80000
    v_mov_b32 v1, 147456
    s_mov_b32 s39, 0x20000
    v_lshrrev_b32 v6, 1, v0
    v_cmp_eq_u32 vcc, 4, v6
    v_lshl_add_u32 v5, v0, 2, v1
    v_mov_b32 v7, 0xff800000
    v_cndmask_b32 v6, 0, v7, vcc
    ds_write_b32 v5, v6 offset:8960
    s_waitcnt lgkmcnt(0)
    s_barrier
    v_lshrrev_b32 v5, 5, v0
    v_and_b32 v6, 31, v0
    v_lshlrev_b32 v7, 1, v5
    v_xor_b32 v6, v6, v7
    v_lshlrev_b32 v6, 4, v6
    v_lshl_or_b32 v8, v5, 9, v6
    v_xor_b32 v9, 64, v8
    v_xor_b32 v10, 0x80, v8
    v_xor_b32 v11, 0xc0, v8
    s_mov_b32 s48, 0
    s_mov_b32 s49, 0
    s_mov_b32 s51, 4096
    s_mov_b32 s54, 16
    s_mov_b32 s38, 131072
    s_lshr_b32 s52, s31, 3
    s_and_b32 s53, s31, 7
    s_lshl_b32 s56, s35, 22
    s_lshl_b32 s41, s33, 17
    s_add_u32 s56, s56, s41
    s_add_u32 s56, s56, 3145728
    s_add_u32 s36, s6, s56
    s_addc_u32 s37, s7, 0
L_kv24:
    s_lshl_b32 s40, s48, 2
    v_add_u32 v6, s40, v1
    ds_read_b32 v7, v6 offset:8996
    s_add_u32 s40, s48, s53
    s_and_b32 s40, s40, 7
    s_lshl_b32 s50, s40, 14
    s_mov_b32 s42, 0
L_grp1:
    s_add_u32 s55, s42, s52
    s_and_b32 s55, s55, 3
    s_lshl_b32 s40, s55, 12
    s_mul_i32 s41, s55, s51
    s_add_u32 m0, s40, s49
    s_add_u32 s41, s41, s50
    s_waitcnt vmcnt(23)
    buffer_load_dwordx4 v8, s[36:39], s41 offen offset:0 nt lds
    s_waitcnt vmcnt(23)
    buffer_load_dwordx4 v9, s[36:39], s41 offen offset:1024 nt lds
    s_waitcnt vmcnt(23)
    buffer_load_dwordx4 v10, s[36:39], s41 offen offset:2048 nt lds
    s_waitcnt vmcnt(23)
    buffer_load_dwordx4 v11, s[36:39], s41 offen offset:3072 nt lds
    s_add_u32 s54, s54, 4
    s_sub_u32 s40, s54, 24
    s_cbranch_scc1 L_nw3
    s_and_b32 s41, s40, 15
    s_cbranch_scc1 L_nw3
    s_lshr_b32 s40, s40, 4
    v_mov_b32 v5, s40
    ds_write_b32 v1, v5 offset:8960
L_nw3:
    s_add_u32 s42, s42, 1
    s_cmp_lt_u32 s42, 4
    s_cbranch_scc1 L_grp1
    s_add_u32 s48, s48, 1
    s_add_u32 s49, s49, 16384
    s_cmp_eq_u32 s49, 147456
    s_cselect_b32 s49, 0, s49
    s_cmp_lt_u32 s48, 8
    s_cbranch_scc1 L_kv24
    s_cmp_eq_u32 s48, 16
    s_cbranch_scc1 L_kvend
    s_add_u32 s36, s8, s56
    s_addc_u32 s37, s9, 0
    s_waitcnt lgkmcnt(0)
    v_readfirstlane_b32 s45, v7
    s_cmp_ge_u32 s45, 8
    s_cbranch_scc1 L_kv24
L_free24:
    ds_read_b32 v5, v6 offset:8996
    s_waitcnt lgkmcnt(0)
    v_readfirstlane_b32 s45, v5
    s_cmp_ge_u32 s45, 8
    s_cbranch_scc1 L_kv24
    s_sleep 1
    s_sub_u32 s60, s60, 1
    s_cbranch_scc0 L_free24
    s_branch L_end
L_kvend:
    s_cmp_lg_u32 s33, 7
    s_cbranch_scc1 L_wo
L_nowo:
    s_waitcnt vmcnt(16)
    v_mov_b32 v5, 16
    ds_write_b32 v1, v5 offset:8960
    s_waitcnt vmcnt(0)
    s_barrier
    s_branch L_ldone
L_wo:
    v_lshrrev_b32 v5, 3, v0
    v_and_b32 v6, 7, v0
    v_lshrrev_b32 v7, 4, v0
    v_lshlrev_b32 v7, 1, v7
    v_xor_b32 v6, v6, v7
    v_lshlrev_b32 v6, 4, v6
    v_mul_u32_u24 v5, 896, v5
    v_add_u32 v12, v5, v6
    v_add_u32 v13, 6144, v12
    v_add_u32 v14, 6144, v13
    v_add_u32 v15, 6144, v14
    s_mov_b32 s36, s12
    s_mov_b32 s37, s13
    s_mov_b32 s38, 3670016
    s_lshl_b32 s40, s30, 1
    s_and_b32 s41, s32, 1
    s_add_u32 s40, s40, s41
    s_mul_i32 s50, s40, 229376
    s_lshl_b32 s41, s33, 7
    s_add_u32 s50, s50, s41
L_w4:
    ds_read_b32 v5, v1 offset:9060
    s_waitcnt lgkmcnt(0)
    v_readfirstlane_b32 s45, v5
    s_cmp_ge_u32 s45, 8
    s_cbranch_scc1 L_d5
    s_sleep 1
    s_sub_u32 s60, s60, 1
    s_cbranch_scc0 L_w4
    s_branch L_end
L_d5:
    s_mov_b32 m0, 114688
    s_nop 0
    buffer_load_dwordx4 v12, s[36:39], s50 offen offset:0 nt lds
    buffer_load_dwordx4 v13, s[36:39], s50 offen offset:1024 nt lds
    buffer_load_dwordx4 v14, s[36:39], s50 offen offset:2048 nt lds
    buffer_load_dwordx4 v15, s[36:39], s50 offen offset:3072 nt lds
    s_mov_b32 m0, 118784
    s_add_u32 s50, s50, 28672
    buffer_load_dwordx4 v12, s[36:39], s50 offen offset:0 nt lds
    buffer_load_dwordx4 v13, s[36:39], s50 offen offset:1024 nt lds
    buffer_load_dwordx4 v14, s[36:39], s50 offen offset:2048 nt lds
    buffer_load_dwordx4 v15, s[36:39], s50 offen offset:3072 nt lds
    s_mov_b32 m0, 122880
    s_add_u32 s50, s50, 28672
    buffer_load_dwordx4 v12, s[36:39], s50 offen offset:0 nt lds
    buffer_load_dwordx4 v13, s[36:39], s50 offen offset:1024 nt lds
    buffer_load_dwordx4 v14, s[36:39], s50 offen offset:2048 nt lds
    buffer_load_dwordx4 v15, s[36:39], s50 offen offset:3072 nt lds
    s_mov_b32 m0, 126976
    s_add_u32 s50, s50, 28672
    buffer_load_dwordx4 v12, s[36:39], s50 offen offset:0 nt lds
    buffer_load_dwordx4 v13, s[36:39], s50 offen offset:1024 nt lds
    buffer_load_dwordx4 v14, s[36:39], s50 offen offset:2048 nt lds
    buffer_load_dwordx4 v15, s[36:39], s50 offen offset:3072 nt lds
    s_mov_b32 m0, 131072
    s_add_u32 s50, s50, 28672
    s_waitcnt vmcnt(39)
    buffer_load_dwordx4 v12, s[36:39], s50 offen offset:0 nt lds
    s_waitcnt vmcnt(39)
    buffer_load_dwordx4 v13, s[36:39], s50 offen offset:1024 nt lds
    s_waitcnt vmcnt(39)
    buffer_load_dwordx4 v14, s[36:39], s50 offen offset:2048 nt lds
    s_waitcnt vmcnt(39)
    buffer_load_dwordx4 v15, s[36:39], s50 offen offset:3072 nt lds
    s_mov_b32 m0, 135168
    s_add_u32 s50, s50, 28672
    s_waitcnt vmcnt(39)
    buffer_load_dwordx4 v12, s[36:39], s50 offen offset:0 nt lds
    s_waitcnt vmcnt(39)
    buffer_load_dwordx4 v13, s[36:39], s50 offen offset:1024 nt lds
    s_waitcnt vmcnt(39)
    buffer_load_dwordx4 v14, s[36:39], s50 offen offset:2048 nt lds
    s_waitcnt vmcnt(39)
    v_mov_b32 v5, 16
    ds_write_b32 v1, v5 offset:8960
    buffer_load_dwordx4 v15, s[36:39], s50 offen offset:3072 nt lds
    s_mov_b32 m0, 139264
    s_add_u32 s50, s50, 28672
    s_waitcnt vmcnt(39)
    buffer_load_dwordx4 v12, s[36:39], s50 offen offset:0 nt lds
    s_waitcnt vmcnt(39)
    buffer_load_dwordx4 v13, s[36:39], s50 offen offset:1024 nt lds
    s_waitcnt vmcnt(39)
    buffer_load_dwordx4 v14, s[36:39], s50 offen offset:2048 nt lds
    s_waitcnt vmcnt(39)
    buffer_load_dwordx4 v15, s[36:39], s50 offen offset:3072 nt lds
    s_mov_b32 m0, 143360
    s_add_u32 s50, s50, 28672
    s_waitcnt vmcnt(39)
    buffer_load_dwordx4 v12, s[36:39], s50 offen offset:0 nt lds
    s_waitcnt vmcnt(39)
    buffer_load_dwordx4 v13, s[36:39], s50 offen offset:1024 nt lds
    s_waitcnt vmcnt(39)
    buffer_load_dwordx4 v14, s[36:39], s50 offen offset:2048 nt lds
    s_waitcnt vmcnt(39)
    buffer_load_dwordx4 v15, s[36:39], s50 offen offset:3072 nt lds
    s_waitcnt vmcnt(32)
    s_barrier
    s_barrier
    s_waitcnt vmcnt(0)
    s_barrier
L_ldone:
    s_waitcnt lgkmcnt(0)
    s_endpgm
L_compute:
    s_load_dwordx8 s[20:27], s[0:1], 64
    s_load_dwordx2 s[28:29], s[0:1], 96
    s_sub_u32 s3, s3, 1
    s_mov_b32 s60, 0x80000
    v_mov_b32 v1, 147456
    s_mov_b32 s39, 0x20000
    v_and_b32 v0, 63, v0
    v_lshlrev_b32 v6, 4, v0
    s_mul_i32 s40, s3, 896
    v_add_u32 v5, s40, v6
    v_mov_b32 v16, 0
    v_mov_b32 v17, 0
    v_mov_b32 v18, 0
    v_mov_b32 v19, 0
    v_lshrrev_b32 v2, 4, v0
    v_and_b32 v3, 15, v0
    v_mov_b32 v4, 1
    v_mov_b32 v15, 0xff
    v_mov_b32 v14, 0
    s_mov_b32 s63, 0xffff0000
    s_lshl_b32 s34, s35, 3
    s_add_u32 s34, s34, s33
    s_lshl_b32 s40, s32, 1
    s_xor_b32 s62, s40, s30
    s_mov_b32 s38, 0x400000
    s_lshl_b32 s40, s30, 2
    s_add_u32 s40, s40, s32
    s_lshl_b32 s40, s40, 3
    s_add_u32 s40, s40, s33
    s_waitcnt lgkmcnt(0)
    s_mov_b32 s26, s40
    s_mov_b32 s27, 163840
    s_mov_b32 s1, 0xffffff00
    s_lshl_b32 s47, s35, 13
    s_lshl_b32 s40, s3, 10
    s_or_b32 s47, s47, s40
    s_or_b32 s47, s47, 262144
    s_cmp_ge_u32 s3, 4
    s_mov_b32 s36, s28
    s_mov_b32 s37, s29
    s_load_dword s61, s[28:29], 0
    s_cbranch_scc1 L_nox
    s_mov_b32 exec_hi, 0x00ffffff
    global_load_dwordx4 v[16:19], v5, s[4:5]
    s_mov_b32 exec_hi, -1
L_nox:
    s_cmp_lg_u32 s3, 0
    s_cbranch_scc1 L_notq0
    v_mov_b32 v7, 0
    global_load_ushort v167, v7, s[22:23]
    s_getreg_b32 s14, hwreg(HW_REG_XCC_ID, 0, 4)
    s_lshl_b32 s59, s30, 7
    s_add_u32 s59, s59, 4096
    s_lshl_b32 s40, s31, 2
    s_add_u32 s40, s40, s59
    s_lshl_b32 s14, s14, 24
    s_waitcnt lgkmcnt(0)
    s_add_u32 s61, s61, 0x9e3779b9
    s_lshr_b32 s0, s61, 8
    s_and_b32 s41, s61, 0xffffff
    s_or_b32 s14, s14, s41
    v_mov_b32 v8, s14
    s_mov_b64 exec, 1
    buffer_store_dword v8, v6, s[36:39], s40 offen
    s_mov_b64 exec, -1
    s_waitcnt vmcnt(2)
    s_branch L_ln
L_notq0:
    s_lshl_b32 s40, s3, 9
    s_sub_u32 s40, s40, 512
    v_lshl_add_u32 v5, v0, 3, s40
    global_load_dwordx2 v[76:77], v5, s[16:17]
    global_load_dwordx2 v[78:79], v5, s[18:19]
    global_load_dwordx2 v[84:85], v5, s[20:21]
    s_xor_b32 s42, s33, 7
    s_or_b32 s42, s42, s62
    s_cbranch_scc1 L_nopf
    s_cmp_lt_u32 s3, 6
    s_cbranch_scc1 L_nopf
    s_getpc_b64 s[40:41]
L_pfpc:
    s_lshl_b32 s42, s3, 10
    s_add_u32 s42, s42, L_pfend-L_pfpc-8192
    s_add_u32 s40, s40, s42
    s_addc_u32 s41, s41, 0
    v_mov_b32 v9, s41
    v_add_co_u32 v8, vcc, s40, v6
    s_nop 1
    v_addc_co_u32 v9, vcc, 0, v9, vcc
    global_load_dwordx4 v[20:23], v[8:9], off
L_nopf:
    s_waitcnt lgkmcnt(0)
    s_add_u32 s61, s61, 0x9e3779b9
    s_lshr_b32 s0, s61, 8
    s_cmp_ge_u32 s3, 4
    s_cbranch_scc1 L_table
    s_waitcnt vmcnt(3)
L_ln:
    s_setprio 2
    v_lshlrev_b32 v20, 16, v16
    v_and_b32 v21, s63, v16
    v_lshlrev_b32 v22, 16, v17
    v_and_b32 v23, s63, v17
    v_lshlrev_b32 v24, 16, v18
    v_and_b32 v25, s63, v18
    v_lshlrev_b32 v26, 16, v19
    v_and_b32 v27, s63, v19
    v_pk_add_f32 v[28:29], v[20:21], v[22:23]
    v_pk_add_f32 v[30:31], v[24:25], v[26:27]
    v_pk_add_f32 v[28:29], v[28:29], v[30:31]
    v_add_f32 v28, v28, v29
    s_nop 1
    v_add_f32_dpp v28, v28, v28 quad_perm:[1,0,3,2] row_mask:0xf bank_mask:0xf
    s_nop 1
    v_add_f32_dpp v28, v28, v28 quad_perm:[2,3,0,1] row_mask:0xf bank_mask:0xf
    s_nop 1
    v_add_f32_dpp v28, v28, v28 row_half_mirror row_mask:0xf bank_mask:0xf
    s_nop 1
    v_add_f32_dpp v28, v28, v28 row_mirror row_mask:0xf bank_mask:0xf
    s_nop 1
    v_add_f32_dpp v28, v28, v28 row_bcast:15 row_mask:0xa bank_mask:0xf
    s_nop 1
    v_add_f32_dpp v28, v28, v28 row_bcast:31 row_mask:0xc bank_mask:0xf
    s_nop 1
    v_readlane_b32 s40, v28, 63
    s_nop 1
    v_mov_b32 v32, 0x3b124925
    v_mul_f32 v30, s40, v32
    v_mov_b32 v28, 0
    s_mov_b32 exec_hi, 0x00ffffff
    v_sub_f32 v29, v20, v30
    v_fmac_f32 v28, v29, v29
    v_sub_f32 v29, v21, v30
    v_fmac_f32 v28, v29, v29
    v_sub_f32 v29, v22, v30
    v_fmac_f32 v28, v29, v29
    v_sub_f32 v29, v23, v30
    v_fmac_f32 v28, v29, v29
    v_sub_f32 v29, v24, v30
    v_fmac_f32 v28, v29, v29
    v_sub_f32 v29, v25, v30
    v_fmac_f32 v28, v29, v29
    v_sub_f32 v29, v26, v30
    v_fmac_f32 v28, v29, v29
    v_sub_f32 v29, v27, v30
    v_fmac_f32 v28, v29, v29
    s_mov_b32 exec_hi, -1
    s_nop 1
    v_add_f32_dpp v28, v28, v28 quad_perm:[1,0,3,2] row_mask:0xf bank_mask:0xf
    s_nop 1
    v_add_f32_dpp v28, v28, v28 quad_perm:[2,3,0,1] row_mask:0xf bank_mask:0xf
    s_nop 1
    v_add_f32_dpp v28, v28, v28 row_half_mirror row_mask:0xf bank_mask:0xf
    s_nop 1
    v_add_f32_dpp v28, v28, v28 row_mirror row_mask:0xf bank_mask:0xf
    s_nop 1
    v_add_f32_dpp v28, v28, v28 row_bcast:15 row_mask:0xa bank_mask:0xf
    s_nop 1
    v_add_f32_dpp v28, v28, v28 row_bcast:31 row_mask:0xc bank_mask:0xf
    s_nop 1
    v_readlane_b32 s41, v28, 63
    s_nop 1
    v_mul_f32 v31, s41, v32
    v_mul_f32 v30, s40, v32
    v_cvt_pk_bf16_f32 v31, 0, abs(v31)
    v_cvt_pk_bf16_f32 v30, 0, v30
    v_add_f32 v31, 0x3727c5ac, v31
    v_cvt_pk_bf16_f32 v31, 0, v31
    v_sqrt_f32 v31, v31
    s_nop 0
    v_cvt_pk_bf16_f32 v31, 0, v31
    v_rcp_f32 v31, v31
    s_nop 0
    v_pk_add_f32 v[20:21], v[20:21], v[30:31] op_sel_hi:[1,0] neg_lo:[0,1] neg_hi:[0,1]
    v_pk_add_f32 v[22:23], v[22:23], v[30:31] op_sel_hi:[1,0] neg_lo:[0,1] neg_hi:[0,1]
    v_pk_add_f32 v[24:25], v[24:25], v[30:31] op_sel_hi:[1,0] neg_lo:[0,1] neg_hi:[0,1]
    v_pk_add_f32 v[26:27], v[26:27], v[30:31] op_sel_hi:[1,0] neg_lo:[0,1] neg_hi:[0,1]
    v_cvt_pk_bf16_f32 v20, 0, v20
    v_cvt_pk_bf16_f32 v21, 0, v21
    v_cvt_pk_bf16_f32 v22, 0, v22
    v_cvt_pk_bf16_f32 v23, 0, v23
    v_cvt_pk_bf16_f32 v24, 0, v24
    v_cvt_pk_bf16_f32 v25, 0, v25
    v_cvt_pk_bf16_f32 v26, 0, v26
    v_cvt_pk_bf16_f32 v27, 0, v27
    v_pk_mul_f32 v[20:21], v[20:21], v[30:31] op_sel:[0,1] op_sel_hi:[1,1]
    v_pk_mul_f32 v[22:23], v[22:23], v[30:31] op_sel:[0,1] op_sel_hi:[1,1]
    v_pk_mul_f32 v[24:25], v[24:25], v[30:31] op_sel:[0,1] op_sel_hi:[1,1]
    v_pk_mul_f32 v[26:27], v[26:27], v[30:31] op_sel:[0,1] op_sel_hi:[1,1]
    v_cvt_pk_bf16_f32 v16, v20, v21
    v_cvt_pk_bf16_f32 v17, v22, v23
    v_cvt_pk_bf16_f32 v18, v24, v25
    v_cvt_pk_bf16_f32 v19, v26, v27
    s_mul_i32 s40, s3, 960
    v_add3_u32 v5, v6, s40, v1
    s_mov_b32 exec_hi, 0x00ffffff
    ds_write_b128 v5, v[16:19] offset:0
    s_mov_b32 exec_hi, -1
    s_mov_b64 exec, 1
    ds_add_u32 v1, v4 offset:8964
    s_mov_b64 exec, -1
    s_cmp_lg_u32 s3, 0
    s_cbranch_scc1 L_table
    v_and_b32 v7, 3, v3
    v_lshlrev_b32 v12, 16, v7
    v_mul_u32_u24 v7, 960, v7
    v_lshl_add_u32 v7, v2, 3, v7
    s_mul_i32 s40, s32, 224
    v_add3_u32 v7, v7, s40, v1
    v_bfe_u32 v8, v0, 3, 2
    v_lshlrev_b32 v8, 5, v8
    v_lshrrev_b32 v9, 2, v0
    v_lshl_or_b32 v8, v9, 7, v8
    v_and_b32 v9, 3, v0
    v_lshl_or_b32 v8, v9, 3, v8
    v_add_u32 v8, 131072, v8
    v_xor_b32 v9, 32, v8
    v_xor_b32 v10, 64, v8
    v_xor_b32 v11, 0x60, v8
    v_lshrrev_b32 v13, 2, v3
    v_cmp_eq_u32 s[52:53], 1, v13
    v_cmp_eq_u32 s[54:55], 2, v13
    v_cmp_eq_u32 s[56:57], 3, v13
    v_lshl_or_b32 v12, v13, 6, v12
    v_lshl_or_b32 v12, v2, 4, v12
    v_mov_b32 v13, 8
    s_lshl_b32 s40, s30, 3
    s_add_u32 s40, s40, s33
    s_lshl_b32 s40, s40, 10
    s_lshl_b32 s41, s32, 8
    s_add_u32 s40, s40, s41
    s_add_u32 s40, s40, 262144
L_w6:
    ds_read_b32 v5, v1 offset:8964
    s_waitcnt lgkmcnt(0)
    v_readfirstlane_b32 s45, v5
    s_cmp_ge_u32 s45, 4
    s_cbranch_scc1 L_d7
    s_sleep 1
    s_sub_u32 s60, s60, 1
    s_cbranch_scc0 L_w6
    s_branch L_end
L_d7:
    ds_read2_b64 v[16:19], v7 offset0:0 offset1:4
    ds_read2_b64 v[20:23], v7 offset0:8 offset1:12
    ds_read2_b64 v[24:27], v7 offset0:16 offset1:20
    ds_read_b64 v[28:29], v7 offset:192
L_w8:
    ds_read_b32 v5, v1 offset:8960
    s_waitcnt lgkmcnt(0)
    v_readfirstlane_b32 s45, v5
    s_cmp_ge_u32 s45, 1
    s_cbranch_scc1 L_d9
    s_sleep 1
    s_sub_u32 s60, s60, 1
    s_cbranch_scc0 L_w8
    s_branch L_end
L_d9:
    ds_read_b64_tr_b16 v[48:49], v8 offset:0
    ds_read_b64_tr_b16 v[50:51], v8 offset:2048
    ds_read_b64_tr_b16 v[52:53], v9 offset:0
    ds_read_b64_tr_b16 v[54:55], v9 offset:2048
    ds_read_b64_tr_b16 v[56:57], v10 offset:0
    ds_read_b64_tr_b16 v[58:59], v10 offset:2048
    ds_read_b64_tr_b16 v[60:61], v11 offset:0
    ds_read_b64_tr_b16 v[62:63], v11 offset:2048
    ds_read_b64_tr_b16 v[64:65], v8 offset:4096
    ds_read_b64_tr_b16 v[66:67], v8 offset:6144
    ds_read_b64_tr_b16 v[68:69], v9 offset:4096
    ds_read_b64_tr_b16 v[70:71], v9 offset:6144
    ds_read_b64_tr_b16 v[72:73], v10 offset:4096
    ds_read_b64_tr_b16 v[74:75], v10 offset:6144
    ds_read_b64_tr_b16 v[76:77], v11 offset:4096
    ds_read_b64_tr_b16 v[78:79], v11 offset:6144
    ds_read_b64_tr_b16 v[80:81], v8 offset:8192
    ds_read_b64_tr_b16 v[82:83], v8 offset:10240
    ds_read_b64_tr_b16 v[84:85], v9 offset:8192
    ds_read_b64_tr_b16 v[86:87], v9 offset:10240
    ds_read_b64_tr_b16 v[88:89], v10 offset:8192
    ds_read_b64_tr_b16 v[90:91], v10 offset:10240
    ds_read_b64_tr_b16 v[92:93], v11 offset:8192
    ds_read_b64_tr_b16 v[94:95], v11 offset:10240
    ds_read_b64_tr_b16 v[96:97], v8 offset:12288
    ds_read_b64_tr_b16 v[100:101], v9 offset:12288
    ds_read_b64_tr_b16 v[104:105], v10 offset:12288
    ds_read_b64_tr_b16 v[108:109], v11 offset:12288
    s_mov_b64 exec, 1
    ds_add_u32 v1, v13 offset:9024
    s_mov_b64 exec, -1
    s_waitcnt lgkmcnt(0)
    v_mfma_f32_16x16x32_bf16 v[112:115], v[48:51], v[16:19], 0
    v_mfma_f32_16x16x32_bf16 v[116:119], v[52:55], v[16:19], 0
    v_mfma_f32_16x16x32_bf16 v[120:123], v[56:59], v[16:19], 0
    v_mfma_f32_16x16x32_bf16 v[124:127], v[60:63], v[16:19], 0
    v_mfma_f32_16x16x32_bf16 v[112:115], v[64:67], v[20:23], v[112:115]
    v_mfma_f32_16x16x32_bf16 v[116:119], v[68:71], v[20:23], v[116:119]
    v_mfma_f32_16x16x32_bf16 v[120:123], v[72:75], v[20:23], v[120:123]
    v_mfma_f32_16x16x32_bf16 v[124:127], v[76:79], v[20:23], v[124:127]
    v_mfma_f32_16x16x32_bf16 v[112:115], v[80:83], v[24:27], v[112:115]
    v_mfma_f32_16x16x32_bf16 v[116:119], v[84:87], v[24:27], v[116:119]
    v_mfma_f32_16x16x32_bf16 v[120:123], v[88:91], v[24:27], v[120:123]
    v_mfma_f32_16x16x32_bf16 v[124:127], v[92:95], v[24:27], v[124:127]
    v_mfma_f32_16x16x16_bf16 v[112:115], v[96:97], v[28:29], v[112:115]
    v_mfma_f32_16x16x16_bf16 v[116:119], v[100:101], v[28:29], v[116:119]
    v_mfma_f32_16x16x16_bf16 v[120:123], v[104:105], v[28:29], v[120:123]
    v_mfma_f32_16x16x16_bf16 v[124:127], v[108:109], v[28:29], v[124:127]
    s_nop 7
    v_cndmask_b32 v112, v112, v116, s[52:53]
    v_cndmask_b32 v113, v113, v117, s[52:53]
    v_cndmask_b32 v114, v114, v118, s[52:53]
    v_cndmask_b32 v115, v115, v119, s[52:53]
    v_cndmask_b32 v112, v112, v120, s[54:55]
    v_cndmask_b32 v113, v113, v121, s[54:55]
    v_cndmask_b32 v114, v114, v122, s[54:55]
    v_cndmask_b32 v115, v115, v123, s[54:55]
    v_cndmask_b32 v112, v112, v124, s[56:57]
    v_cndmask_b32 v113, v113, v125, s[56:57]
    v_cndmask_b32 v114, v114, v126, s[56:57]
    v_cndmask_b32 v115, v115, v127, s[56:57]
    v_add_u32 v112, 0x80, v112
    v_add_u32 v113, 0x80, v113
    v_add_u32 v114, 0x80, v114
    v_add_u32 v115, 0x80, v115
    v_bfi_b32 v112, v15, s61, v112
    v_bfi_b32 v113, v15, s61, v113
    v_bfi_b32 v114, v15, s0, v114
    v_bfi_b32 v115, v15, s0, v115
    buffer_store_dwordx4 v[112:115], v12, s[36:39], s40 offen
    s_add_u32 s58, s40, 2097152
    v_mov_b32 v14, v12
    s_branch L_qk
L_table:
    s_setprio 0
    s_waitcnt vmcnt(0)
    v_lshlrev_b32 v48, 16, v76
    v_and_b32 v49, s63, v76
    v_lshlrev_b32 v50, 16, v77
    v_and_b32 v51, s63, v77
    v_lshlrev_b32 v52, 16, v78
    v_and_b32 v53, s63, v78
    v_lshlrev_b32 v54, 16, v79
    v_and_b32 v55, s63, v79
    v_lshlrev_b32 v56, 16, v84
    v_and_b32 v57, s63, v84
    v_lshlrev_b32 v58, 16, v85
    v_and_b32 v59, s63, v85
    v_mov_b32 v47, 0xbdd2d3e8
    s_and_b32 s40, s26, 127
    s_mul_i32 s40, s40, 24
    s_add_u32 s40, s40, 13824
    s_lshr_b32 s41, s26, 7
    s_lshl_b32 s41, s41, 15
    s_or_b32 s40, s40, s41
    s_lshl_b32 s50, s40, 16
    s_mov_b32 s54, 0
    s_lshl_b32 s40, s3, 7
    v_lshl_add_u32 v8, v2, 2, v1
    v_add_u32 v8, s40, v8
L_tloop:
    s_cmp_lg_u32 s54, 20
    s_cbranch_scc1 L_tnoq
    buffer_load_dwordx4 v[20:23], v6, s[36:39], s47 offen sc1
L_tnoq:
    s_add_u32 s51, s50, 0x10000
    s_add_u32 s52, s50, 0x20000
    s_add_u32 s53, s50, 0x30000
    v_fma_f32 v60, s50, v48, v52
    v_fma_f32 v64, s51, v48, v52
    v_fma_f32 v61, s50, v49, v53
    v_fma_f32 v65, s51, v49, v53
    v_fma_f32 v62, s50, v50, v54
    v_fma_f32 v66, s51, v50, v54
    v_fma_f32 v63, s50, v51, v55
    v_fma_f32 v67, s51, v51, v55
    v_mul_f32 v68, v60, v60
    v_mul_f32 v72, v64, v64
    v_mul_f32 v69, v61, v61
    v_mul_f32 v73, v65, v65
    v_mul_f32 v70, v62, v62
    v_mul_f32 v74, v66, v66
    v_mul_f32 v71, v63, v63
    v_mul_f32 v75, v67, v67
    v_fmaak_f32 v68, v68, v47, 0xc0135761
    v_fmaak_f32 v72, v72, v47, 0xc0135761
    v_fmaak_f32 v69, v69, v47, 0xc0135761
    v_fmaak_f32 v73, v73, v47, 0xc0135761
    v_fmaak_f32 v70, v70, v47, 0xc0135761
    v_fmaak_f32 v74, v74, v47, 0xc0135761
    v_fmaak_f32 v71, v71, v47, 0xc0135761
    v_fmaak_f32 v75, v75, v47, 0xc0135761
    v_mul_f32 v68, v68, v60
    v_mul_f32 v72, v72, v64
    v_mul_f32 v69, v69, v61
    v_mul_f32 v73, v73, v65
    v_mul_f32 v70, v70, v62
    v_mul_f32 v74, v74, v66
    v_mul_f32 v71, v71, v63
    v_mul_f32 v75, v75, v67
    v_exp_f32 v68, v68
    v_mul_f32 v60, v60, v56
    v_exp_f32 v72, v72
    v_mul_f32 v64, v64, v56
    v_exp_f32 v69, v69
    v_mul_f32 v61, v61, v57
    v_exp_f32 v73, v73
    v_mul_f32 v65, v65, v57
    v_exp_f32 v70, v70
    v_mul_f32 v62, v62, v58
    v_exp_f32 v74, v74
    v_mul_f32 v66, v66, v58
    v_exp_f32 v71, v71
    v_mul_f32 v63, v63, v59
    v_exp_f32 v75, v75
    v_mul_f32 v67, v67, v59
    v_add_f32 v68, 1.0, v68
    v_add_f32 v72, 1.0, v72
    v_add_f32 v69, 1.0, v69
    v_add_f32 v73, 1.0, v73
    v_add_f32 v70, 1.0, v70
    v_add_f32 v74, 1.0, v74
    v_add_f32 v71, 1.0, v71
    v_add_f32 v75, 1.0, v75
    v_rcp_f32 v68, v68
    v_rcp_f32 v72, v72
    v_rcp_f32 v69, v69
    v_rcp_f32 v73, v73
    v_rcp_f32 v70, v70
    v_rcp_f32 v74, v74
    v_rcp_f32 v71, v71
    v_rcp_f32 v75, v75
    s_nop 0
    v_mul_f32 v80, v60, v68
    v_mul_f32 v81, v64, v72
    v_fmac_f32 v80, v61, v69
    v_fmac_f32 v81, v65, v73
    v_fmac_f32 v80, v62, v70
    v_fmac_f32 v81, v66, v74
    v_fmac_f32 v80, v63, v71
    v_fmac_f32 v81, v67, v75
    v_fma_f32 v60, s52, v48, v52
    v_fma_f32 v64, s53, v48, v52
    v_fma_f32 v61, s52, v49, v53
    v_fma_f32 v65, s53, v49, v53
    v_fma_f32 v62, s52, v50, v54
    v_fma_f32 v66, s53, v50, v54
    v_fma_f32 v63, s52, v51, v55
    v_fma_f32 v67, s53, v51, v55
    v_mul_f32 v68, v60, v60
    v_mul_f32 v72, v64, v64
    v_mul_f32 v69, v61, v61
    v_mul_f32 v73, v65, v65
    v_mul_f32 v70, v62, v62
    v_mul_f32 v74, v66, v66
    v_mul_f32 v71, v63, v63
    v_mul_f32 v75, v67, v67
    v_fmaak_f32 v68, v68, v47, 0xc0135761
    v_fmaak_f32 v72, v72, v47, 0xc0135761
    v_fmaak_f32 v69, v69, v47, 0xc0135761
    v_fmaak_f32 v73, v73, v47, 0xc0135761
    v_fmaak_f32 v70, v70, v47, 0xc0135761
    v_fmaak_f32 v74, v74, v47, 0xc0135761
    v_fmaak_f32 v71, v71, v47, 0xc0135761
    v_fmaak_f32 v75, v75, v47, 0xc0135761
    v_mul_f32 v68, v68, v60
    v_mul_f32 v72, v72, v64
    v_mul_f32 v69, v69, v61
    v_mul_f32 v73, v73, v65
    v_mul_f32 v70, v70, v62
    v_mul_f32 v74, v74, v66
    v_mul_f32 v71, v71, v63
    v_mul_f32 v75, v75, v67
    v_exp_f32 v68, v68
    v_mul_f32 v60, v60, v56
    v_exp_f32 v72, v72
    v_mul_f32 v64, v64, v56
    v_exp_f32 v69, v69
    v_mul_f32 v61, v61, v57
    v_exp_f32 v73, v73
    v_mul_f32 v65, v65, v57
    v_exp_f32 v70, v70
    v_mul_f32 v62, v62, v58
    v_exp_f32 v74, v74
    v_mul_f32 v66, v66, v58
    v_exp_f32 v71, v71
    v_mul_f32 v63, v63, v59
    v_exp_f32 v75, v75
    v_mul_f32 v67, v67, v59
    v_add_f32 v68, 1.0, v68
    v_add_f32 v72, 1.0, v72
    v_add_f32 v69, 1.0, v69
    v_add_f32 v73, 1.0, v73
    v_add_f32 v70, 1.0, v70
    v_add_f32 v74, 1.0, v74
    v_add_f32 v71, 1.0, v71
    v_add_f32 v75, 1.0, v75
    v_rcp_f32 v68, v68
    v_rcp_f32 v72, v72
    v_rcp_f32 v69, v69
    v_rcp_f32 v73, v73
    v_rcp_f32 v70, v70
    v_rcp_f32 v74, v74
    v_rcp_f32 v71, v71
    v_rcp_f32 v75, v75
    s_nop 0
    v_mul_f32 v82, v60, v68
    v_mul_f32 v83, v64, v72
    v_fmac_f32 v82, v61, v69
    v_fmac_f32 v83, v65, v73
    v_fmac_f32 v82, v62, v70
    v_fmac_f32 v83, v66, v74
    v_fmac_f32 v82, v63, v71
    v_fmac_f32 v83, v67, v75
    s_nop 0
    v_permlane16_swap_b32 v80, v81
    v_permlane16_swap_b32 v82, v83
    v_add_f32 v80, v80, v81
    v_add_f32 v82, v82, v83
    s_nop 1
    v_permlane32_swap_b32 v80, v82
    v_add_f32 v80, v80, v82
    s_add_u32 s50, s50, 0x40000
    s_add_u32 s54, s54, 4
    v_add_f32_dpp v80, v80, v80 quad_perm:[1,0,3,2] row_mask:0xf bank_mask:0xf
    s_nop 1
    v_add_f32_dpp v80, v80, v80 quad_perm:[2,3,0,1] row_mask:0xf bank_mask:0xf
    s_nop 1
    v_add_f32_dpp v80, v80, v80 row_half_mirror row_mask:0xf bank_mask:0xf
    s_nop 1
    v_add_f32_dpp v80, v80, v80 row_mirror row_mask:0xf bank_mask:0xf
    s_nop 1
    s_cmp_lt_u32 s54, 24
    ds_write_b32 v8, v80 offset:7808
    v_add_u32 v8, 16, v8
    s_cbranch_scc1 L_tloop
    s_mov_b64 exec, 1
    ds_add_u32 v1, v4 offset:8980
    s_mov_b64 exec, -1
L_qk:
    s_setprio 1
    v_and_b32 v8, 7, v3
    v_lshlrev_b32 v8, 1, v8
    v_xor_b32 v8, v8, v2
    v_lshlrev_b32 v8, 4, v8
    v_lshl_or_b32 v8, v3, 9, v8
    s_lshl_b32 s40, s3, 14
    v_add_u32 v8, s40, v8
    v_xor_b32 v9, 64, v8
    v_xor_b32 v10, 0x80, v8
    v_xor_b32 v11, 0xc0, v8
    s_lshl_b32 s40, s3, 2
    v_add_u32 v12, s40, v1
    v_mov_b32 v13, 8
    s_add_u32 s44, s3, 2
L_w10:
    ds_read_b32 v5, v1 offset:8960
    s_waitcnt lgkmcnt(0)
    v_readfirstlane_b32 s45, v5
    s_cmp_ge_u32 s45, s44
    s_cbranch_scc1 L_d11
    s_sleep 1
    s_sub_u32 s60, s60, 1
    s_cbranch_scc0 L_w10
    s_branch L_end
L_d11:
    ds_read_b128 v[48:51], v8 offset:0
    ds_read_b128 v[52:55], v8 offset:8192
    ds_read_b128 v[56:59], v9 offset:0
    ds_read_b128 v[60:63], v9 offset:8192
    ds_read_b128 v[64:67], v10 offset:0
    ds_read_b128 v[68:71], v10 offset:8192
    ds_read_b128 v[72:75], v11 offset:0
    ds_read_b128 v[76:79], v11 offset:8192
    ds_read_b128 v[80:83], v8 offset:256
    ds_read_b128 v[84:87], v8 offset:8448
    ds_read_b128 v[88:91], v9 offset:256
    ds_read_b128 v[92:95], v9 offset:8448
    ds_read_b128 v[96:99], v10 offset:256
    ds_read_b128 v[100:103], v10 offset:8448
    ds_read_b128 v[104:107], v11 offset:256
    ds_read_b128 v[108:111], v11 offset:8448
    s_mov_b64 exec, 1
    ds_add_u32 v12, v13 offset:9028
    s_mov_b64 exec, -1
    s_lshr_b32 s41, s3, 2
    s_mul_i32 s41, s41, 576
    s_and_b32 s42, s3, 3
    s_lshl_b32 s42, s42, 7
    s_add_u32 s41, s41, s42
    v_lshlrev_b32 v12, 1, v2
    v_lshl_or_b32 v12, v3, 3, v12
    v_add3_u32 v12, v12, s41, v1
    s_cmp_lg_u32 s3, 0
    s_cbranch_scc1 L_qchk
L_w12:
    ds_read_b32 v5, v1 offset:8960
    s_waitcnt lgkmcnt(0)
    v_readfirstlane_b32 s45, v5
    s_cmp_ge_u32 s45, 5
    s_cbranch_scc1 L_d13
    s_sleep 1
    s_sub_u32 s60, s60, 1
    s_cbranch_scc0 L_w12
    s_branch L_end
L_d13:
    buffer_load_dwordx4 v[20:23], v6, s[36:39], s47 offen sc1
    v_and_b32 v16, 31, v0
    v_lshlrev_b32 v16, 2, v16
    buffer_load_dword v17, v16, s[36:39], s59 offen sc1
    s_waitcnt vmcnt(0)
    v_cmp_ne_u32 vcc, s14, v17
    v_mov_b32 v17, 1
    s_cmp_lg_u64 vcc, 0
    s_cbranch_scc1 L_idfar
L_idloc:
    ds_write_b32 v1, v17 offset:8988
L_qchk:
    s_waitcnt vmcnt(0)
    v_bitop3_b32 v5, v20, v21, s61 bitop3:0x7e
    v_bitop3_b32 v7, v22, v23, s0 bitop3:0x7e
    v_or_b32 v5, v5, v7
    v_cmp_ne_u32_sdwa vcc, v5, 0 src0_sel:BYTE_0 src1_sel:DWORD
    s_cmp_eq_u64 vcc, 0
    s_cbranch_scc1 L_qok
L_w14:
    ds_read_b32 v5, v1 offset:8988
    s_waitcnt lgkmcnt(0)
    v_readfirstlane_b32 s45, v5
    s_cmp_ge_u32 s45, 1
    s_cbranch_scc1 L_d15
    s_sleep 8
    s_sub_u32 s60, s60, 1
    s_cbranch_scc0 L_w14
    s_branch L_end
L_d15:
    s_sub_u32 s45, s45, 1
    s_xor_b32 s47, s47, s45
    s_sleep 8
    buffer_load_dwordx4 v[20:23], v6, s[36:39], s47 offen sc1
    s_sub_u32 s60, s60, 1
    s_cbranch_scc0 L_qchk
    s_branch L_end
L_qok:
    v_and_b32 v20, s1, v20
    v_and_b32 v21, s1, v21
    v_and_b32 v22, s1, v22
    v_and_b32 v23, s1, v23
    s_nop 0
    v_permlane16_swap_b32 v20, v21
    v_permlane16_swap_b32 v22, v23
    v_add_f32 v20, v20, v21
    v_add_f32 v22, v22, v23
    s_nop 1
    v_permlane32_swap_b32 v20, v22
    v_add_f32 v20, v20, v22
    v_cvt_pk_bf16_f32 v20, v20, v20
    ds_write_b16 v12, v20 offset:4096
    s_mov_b64 exec, 1
    ds_add_u32 v1, v4 offset:8968
    s_mov_b64 exec, -1
    v_and_b32 v7, 1, v3
    v_lshl_add_u32 v8, v7, 2, v1
    v_mul_u32_u24 v7, 576, v7
    v_lshl_add_u32 v7, v2, 4, v7
    v_add_u32 v7, v7, v1
    s_lshl_b32 s40, s3, 6
    v_add_u32 v9, s40, v7
    s_mov_b32 s46, 0x3db8aa3b
L_w16:
    ds_read_b32 v5, v1 offset:8968
    s_waitcnt lgkmcnt(0)
    v_readfirstlane_b32 s45, v5
    s_cmp_ge_u32 s45, 8
    s_cbranch_scc1 L_d17
    s_sleep 1
    s_sub_u32 s60, s60, 1
    s_cbranch_scc0 L_w16
    s_branch L_end
L_d17:
    ds_read_b32 v5, v1 offset:8988
    ds_read_b128 v[16:19], v7 offset:4096
    ds_read_b128 v[20:23], v7 offset:4160
    ds_read_b128 v[24:27], v7 offset:4224
    ds_read_b128 v[28:31], v7 offset:4288
    ds_read_b128 v[32:35], v7 offset:4352
    ds_read_b128 v[36:39], v7 offset:4416
    ds_read_b128 v[40:43], v7 offset:4480
    ds_read_b128 v[44:47], v7 offset:4544
    s_waitcnt lgkmcnt(7)
    v_readfirstlane_b32 s15, v5
    v_mfma_f32_16x16x32_bf16 v[112:115], v[48:51], v[16:19], 0
    v_mfma_f32_16x16x32_bf16 v[116:119], v[52:55], v[16:19], 0
    s_waitcnt lgkmcnt(6)
    v_mfma_f32_16x16x32_bf16 v[112:115], v[56:59], v[20:23], v[112:115]
    v_mfma_f32_16x16x32_bf16 v[116:119], v[60:63], v[20:23], v[116:119]
    s_waitcnt lgkmcnt(5)
    v_mfma_f32_16x16x32_bf16 v[112:115], v[64:67], v[24:27], v[112:115]
    v_mfma_f32_16x16x32_bf16 v[116:119], v[68:71], v[24:27], v[116:119]
    s_waitcnt lgkmcnt(4)
    v_mfma_f32_16x16x32_bf16 v[112:115], v[72:75], v[28:31], v[112:115]
    v_mfma_f32_16x16x32_bf16 v[116:119], v[76:79], v[28:31], v[116:119]
    s_waitcnt lgkmcnt(3)
    v_mfma_f32_16x16x32_bf16 v[112:115], v[80:83], v[32:35], v[112:115]
    v_mfma_f32_16x16x32_bf16 v[116:119], v[84:87], v[32:35], v[116:119]
    s_waitcnt lgkmcnt(2)
    v_mfma_f32_16x16x32_bf16 v[112:115], v[88:91], v[36:39], v[112:115]
    v_mfma_f32_16x16x32_bf16 v[116:119], v[92:95], v[36:39], v[116:119]
    s_waitcnt lgkmcnt(1)
    v_mfma_f32_16x16x32_bf16 v[112:115], v[96:99], v[40:43], v[112:115]
    v_mfma_f32_16x16x32_bf16 v[116:119], v[100:103], v[40:43], v[116:119]
    s_waitcnt lgkmcnt(0)
    v_mfma_f32_16x16x32_bf16 v[112:115], v[104:107], v[44:47], v[112:115]
    v_mfma_f32_16x16x32_bf16 v[116:119], v[108:111], v[44:47], v[116:119]
    s_sub_u32 s15, s15, 1
    s_nop 6
    v_cvt_pk_bf16_f32 v112, 0, v112
    v_cvt_pk_bf16_f32 v113, 0, v113
    v_cvt_pk_bf16_f32 v114, 0, v114
    v_cvt_pk_bf16_f32 v115, 0, v115
    v_cvt_pk_bf16_f32 v116, 0, v116
    v_cvt_pk_bf16_f32 v117, 0, v117
    v_cvt_pk_bf16_f32 v118, 0, v118
    v_cvt_pk_bf16_f32 v119, 0, v119
    v_max3_f32 v120, v112, v113, v114
    v_max3_f32 v121, v115, v116, v117
    v_max3_f32 v120, v120, v118, v119
    v_max_f32 v120, v120, v121
    s_mov_b32 exec_lo, 0x00030003
    s_mov_b32 exec_hi, 0x00030003
    ds_max_f32 v8, v120 offset:8992
    s_mov_b64 exec, -1
    s_mov_b64 exec, 1
    ds_add_u32 v1, v4 offset:8972
    s_mov_b64 exec, -1
L_w18:
    ds_read_b32 v5, v1 offset:8972
    s_waitcnt lgkmcnt(0)
    v_readfirstlane_b32 s45, v5
    s_cmp_ge_u32 s45, 8
    s_cbranch_scc1 L_d19
    s_sleep 1
    s_sub_u32 s60, s60, 1
    s_cbranch_scc0 L_w18
    s_branch L_end
L_d19:
    ds_read_b32 v124, v8 offset:8992
    s_waitcnt lgkmcnt(0)
    v_sub_f32 v112, v112, v124
    v_sub_f32 v113, v113, v124
    v_sub_f32 v114, v114, v124
    v_sub_f32 v115, v115, v124
    v_sub_f32 v116, v116, v124
    v_sub_f32 v117, v117, v124
    v_sub_f32 v118, v118, v124
    v_sub_f32 v119, v119, v124
    v_mul_f32 v112, s46, v112
    v_mul_f32 v113, s46, v113
    v_mul_f32 v114, s46, v114
    v_mul_f32 v115, s46, v115
    v_mul_f32 v116, s46, v116
    v_mul_f32 v117, s46, v117
    v_mul_f32 v118, s46, v118
    v_mul_f32 v119, s46, v119
    v_exp_f32 v112, v112
    v_exp_f32 v113, v113
    v_exp_f32 v114, v114
    v_exp_f32 v115, v115
    v_exp_f32 v116, v116
    v_exp_f32 v117, v117
    v_exp_f32 v118, v118
    v_exp_f32 v119, v119
    s_nop 0
    v_cvt_pk_bf16_f32 v120, v112, v113
    v_cvt_pk_bf16_f32 v121, v114, v115
    v_cvt_pk_bf16_f32 v122, v116, v117
    v_cvt_pk_bf16_f32 v123, v118, v119
    s_mov_b32 exec_lo, 0x00030003
    s_mov_b32 exec_hi, 0x00030003
    ds_write_b128 v9, v[120:123] offset:5376
    s_mov_b64 exec, -1
    s_mov_b64 exec, 1
    ds_add_u32 v1, v4 offset:8976
    s_mov_b64 exec, -1
    v_mov_b32 v43, v7
    v_bfe_u32 v8, v0, 2, 3
    s_lshl_b32 s40, s3, 1
    v_xor_b32 v8, s40, v8
    v_lshlrev_b32 v8, 5, v8
    v_lshrrev_b32 v9, 2, v0
    v_lshl_or_b32 v8, v9, 9, v8
    v_and_b32 v10, 3, v0
    v_lshl_or_b32 v44, v10, 3, v8
    v_xor_b32 v45, 32, v44
    v_mov_b32 v112, 0
    v_mov_b32 v113, 0
    v_mov_b32 v114, 0
    v_mov_b32 v115, 0
    v_mov_b32 v116, 0
    v_mov_b32 v117, 0
    v_mov_b32 v118, 0
    v_mov_b32 v119, 0
    v_and_b32 v28, 1, v3
    v_lshlrev_b32 v28, 10, v28
    v_bfe_u32 v29, v3, 1, 1
    v_lshl_or_b32 v28, v29, 6, v28
    v_lshl_or_b32 v160, v2, 4, v28
    v_cmp_ne_u32 s[56:57], 0, v29
    s_lshl_b32 s51, s34, 11
    s_lshl_b32 s40, s3, 7
    s_add_u32 s51, s51, s40
    s_add_u32 s51, s51, 524288
    v_lshlrev_b32 v161, 6, v2
    v_lshlrev_b32 v28, 4, v3
    v_lshl_or_b32 v162, v2, 11, v28
    s_and_b32 s42, s35, 0x17
    s_lshr_b32 s41, s3, 2
    s_lshl_b32 s41, s41, 3
    s_add_u32 s42, s42, s41
    s_and_b32 s43, s32, 1
    s_lshl_b32 s52, s42, 14
    s_lshl_b32 s41, s43, 10
    s_add_u32 s52, s52, s41
    s_and_b32 s41, s3, 3
    s_lshl_b32 s41, s41, 8
    s_add_u32 s52, s52, s41
    s_add_u32 s52, s52, 524288
    s_add_u32 s59, s52, 8192
    v_bfe_u32 v28, v0, 3, 2
    s_and_b32 s41, s3, 3
    v_xor_b32 v28, s41, v28
    v_lshlrev_b32 v28, 5, v28
    v_lshl_or_b32 v28, v9, 7, v28
    v_lshl_or_b32 v163, v10, 3, v28
    v_add_u32 v164, 114688, v163
    v_lshlrev_b32 v28, 4, v10
    v_bfe_u32 v29, v0, 2, 1
    v_lshl_or_b32 v28, v29, 3, v28
    v_bfe_u32 v29, v0, 3, 1
    v_lshl_or_b32 v28, v29, 6, v28
    v_lshl_or_b32 v28, v2, 1, v28
    s_lshr_b32 s40, s3, 2
    s_mul_i32 s40, s40, 576
    s_lshl_b32 s41, s41, 7
    s_add_u32 s40, s40, s41
    v_add3_u32 v165, v28, s40, v1
    s_lshl_b32 s40, s3, 6
    v_add_u32 v166, 1280, v7
    v_mul_u32_u24 v14, 28672, v3
    v_lshl_add_u32 v14, v2, 4, v14
    s_and_b32 s53, s32, 2
    s_lshl_b32 s53, s53, 3
    s_add_u32 s53, s53, s30
    s_lshl_b32 s53, s53, 1
    s_add_u32 s53, s53, s43
    s_mul_i32 s53, s53, 1792
    s_lshl_b32 s41, s33, 8
    s_add_u32 s53, s53, s41
    s_add_u32 s53, s53, s40
    s_add_u32 s53, s53, 1048576
    s_lshl_b32 s54, s42, 9
    s_lshl_b32 s41, s43, 3
    s_add_u32 s54, s54, s41
    s_add_u32 s54, s54, 196608
    v_lshl_add_u32 v136, v3, 2, v2
    v_add_u32 v136, s40, v136
    s_mul_i32 s41, s32, 896
    v_lshl_add_u32 v137, v136, 1, s41
    s_and_b32 s55, s26, 0xf8
    s_mul_i32 s55, s55, 96
    s_xor_b32 s41, s33, 7
    s_or_b32 s62, s62, s41
    s_xor_b32 s40, s33, 7
    s_xor_b32 s41, s3, 7
    s_or_b32 s40, s40, s41
    s_cbranch_scc1 L_notpre
    v_lshlrev_b32 v28, 7, v0
    s_add_u32 s40, s55, 131072
    s_mov_b64 exec, 63
    buffer_load_dword v128, v28, s[36:39], s40 offen sc1
    s_mov_b64 exec, -1
L_notpre:
    s_and_b32 s40, s3, 5
    s_cbranch_scc1 L_nopre
    s_cmp_eq_u32 s33, 7
    s_cbranch_scc1 L_nopre
    s_mov_b64 exec, 3
    s_mov_b32 s40, s53
    buffer_load_dword v128, v14, s[36:39], s40 offen sc1
    s_sub_u32 s40, s40, 0x20000
    s_mov_b64 exec, -1
L_nopre:
L_w20:
    ds_read_b32 v5, v1 offset:8976
    s_waitcnt lgkmcnt(0)
    v_readfirstlane_b32 s45, v5
    s_cmp_ge_u32 s45, 8
    s_cbranch_scc1 L_d21
    s_sleep 1
    s_sub_u32 s60, s60, 1
    s_cbranch_scc0 L_w20
    s_branch L_end
L_d21:
    s_cmp_lg_u32 s3, 0
    s_cbranch_scc1 L_nostat
    ds_read_b128 v[48:51], v43 offset:5376
    ds_read_b128 v[52:55], v43 offset:5440
    ds_read_b128 v[56:59], v43 offset:5504
    ds_read_b128 v[60:63], v43 offset:5568
    ds_read_b128 v[64:67], v43 offset:5632
    ds_read_b128 v[68:71], v43 offset:5696
    ds_read_b128 v[72:75], v43 offset:5760
    ds_read_b128 v[76:79], v43 offset:5824
    v_mov_b32 v16, 0x3f803f80
    v_mov_b32 v17, 0x3f803f80
    v_mov_b32 v18, 0x3f803f80
    v_mov_b32 v19, 0x3f803f80
    s_lshl_b32 s40, s34, 6
    s_add_u32 s40, s40, 196608
    s_waitcnt lgkmcnt(0)
    v_mfma_f32_16x16x32_bf16 v[20:23], v[16:19], v[48:51], 0
    v_mfma_f32_16x16x32_bf16 v[20:23], v[16:19], v[52:55], v[20:23]
    v_mfma_f32_16x16x32_bf16 v[20:23], v[16:19], v[56:59], v[20:23]
    v_mfma_f32_16x16x32_bf16 v[20:23], v[16:19], v[60:63], v[20:23]
    v_mfma_f32_16x16x32_bf16 v[20:23], v[16:19], v[64:67], v[20:23]
    v_mfma_f32_16x16x32_bf16 v[20:23], v[16:19], v[68:71], v[20:23]
    v_mfma_f32_16x16x32_bf16 v[20:23], v[16:19], v[72:75], v[20:23]
    v_mfma_f32_16x16x32_bf16 v[20:23], v[16:19], v[76:79], v[20:23]
    v_mov_b32_dpp v126, v124 quad_perm:[1,0,3,2] row_mask:0xf bank_mask:0xf
    s_nop 6
    v_mov_b32 v125, v20
    v_mov_b32_dpp v127, v20 quad_perm:[1,0,3,2] row_mask:0xf bank_mask:0xf
    v_add_u32 v125, 0x80, v125
    v_add_u32 v127, 0x80, v127
    v_bfi_b32 v125, v15, s0, v125
    v_bfi_b32 v127, v15, s0, v127
    v_bfi_b32 v124, v15, s61, v124
    v_bfi_b32 v126, v15, s61, v126
    s_mov_b64 exec, 1
    buffer_store_dwordx4 v[124:127], v6, s[36:39], s40 offen
    s_cmp_lg_u32 s15, 0
    s_cbranch_scc1 L_far22
L_pub23:
    s_mov_b64 exec, -1
    v_and_b32 v7, 31, v0
    v_lshl_add_u32 v7, v7, 2, v1
L_w24:
    ds_read_b32 v5, v1 offset:8980
    s_waitcnt lgkmcnt(0)
    v_readfirstlane_b32 s45, v5
    s_cmp_ge_u32 s45, 7
    s_cbranch_scc1 L_d25
    s_sleep 1
    s_sub_u32 s60, s60, 1
    s_cbranch_scc0 L_w24
    s_branch L_end
L_d25:
    ds_read_b32 v16, v7 offset:7936
    ds_read_b32 v17, v7 offset:8064
    ds_read_b32 v18, v7 offset:8192
    ds_read_b32 v19, v7 offset:8320
    ds_read_b32 v20, v7 offset:8448
    ds_read_b32 v21, v7 offset:8576
    ds_read_b32 v22, v7 offset:8704
    s_mul_i32 s40, s26, 96
    s_add_u32 s40, s40, 163840
    v_lshlrev_b32 v8, 2, v0
    v_lshlrev_b32 v46, 16, v167
    s_waitcnt lgkmcnt(0)
    v_add_f32 v16, v16, v17
    v_add_f32 v18, v18, v19
    v_add_f32 v20, v20, v21
    v_add_f32 v16, v16, v18
    v_add_f32 v20, v20, v22
    v_add_f32 v16, v16, v20
    v_cvt_pk_bf16_f32 v16, 0, v16
    v_add_f32 v16, v16, v46
    v_cvt_pk_bf16_f32 v16, 0, v16
    v_mov_b32 v17, s61
    v_bfi_b32 v16, s63, v16, v17
    s_mov_b64 exec, 16777215
    buffer_store_dword v16, v8, s[36:39], s40 offen
    s_cmp_lg_u32 s15, 0
    s_cbranch_scc1 L_far26
L_pub27:
    s_mov_b64 exec, -1
L_nostat:
    s_mov_b32 s48, 0
    s_mov_b32 s49, 131072
    s_mov_b32 s50, 6
    v_add_u32 v12, 9060, v1
    s_mov_b32 s44, 10
    s_cmp_eq_u32 s33, 7
    s_cselect_b32 s58, 0, 2
L_pv:
    ds_read_b128 v[16:19], v43 offset:5376
    v_add_u32 v10, s49, v44
    v_add_u32 v11, s49, v45
    s_cmp_lg_u32 s48, 7
    s_waitcnt lgkmcnt(0)
    s_cbranch_scc1 L_pvwait
    s_barrier
L_pvgo:
    ds_read_b64_tr_b16 v[20:21], v10
    ds_read_b64_tr_b16 v[22:23], v10 offset:8192
    ds_read_b64_tr_b16 v[24:25], v11
    ds_read_b64_tr_b16 v[26:27], v11 offset:8192
    s_mov_b64 exec, 1
    ds_add_u32 v12, v4 offset:0
    s_mov_b64 exec, -1
    v_add_u32 v43, 64, v43
    s_add_u32 s48, s48, 1
    v_add_u32 v12, 4, v12
    s_add_u32 s44, s44, 1
    s_add_u32 s49, s49, 16384
    s_cmp_eq_u32 s49, 147456
    s_cselect_b32 s49, 0, s49
    s_cmp_lt_u32 s48, s50
    s_waitcnt lgkmcnt(3)
    v_mfma_f32_16x16x32_bf16 v[112:115], v[20:23], v[16:19], v[112:115]
    s_waitcnt lgkmcnt(1)
    v_mfma_f32_16x16x32_bf16 v[116:119], v[24:27], v[16:19], v[116:119]
    s_cbranch_scc1 L_pv
    s_cmp_eq_u32 s48, 8
    s_cbranch_scc1 L_pv_done
    s_mov_b32 s50, 8
    s_cmp_eq_u32 s33, 7
    s_cbranch_scc1 L_mid7
    buffer_load_dwordx2 v[32:33], v161, s[36:39], s54 offen sc1
    buffer_load_dwordx2 v[34:35], v161, s[36:39], s54 offen offset:256 sc1
    s_branch L_pv
L_mid7:
    s_cmp_lg_u32 s3, 0
    s_cbranch_scc1 L_mid8
    v_mov_b32 v32, s61
    v_mov_b32 v33, s61
    v_mov_b32 v34, s61
    v_mov_b32 v35, s61
    s_add_u32 s54, s55, 163840
    s_mov_b32 exec_hi, 0xffff
    buffer_load_dwordx4 v[32:35], v6, s[36:39], s54 offen sc1
    s_mov_b32 exec_hi, -1
L_mid8:
    s_cmp_lg_u32 s62, 0
    s_cbranch_scc1 L_pv
    s_cmp_eq_u32 s3, 7
    s_cbranch_scc1 L_pv
    global_load_ushort v138, v137, s[4:5]
    s_branch L_pv
L_pvwait:
    ds_read_b32 v5, v1 offset:8960
    s_waitcnt lgkmcnt(0)
    v_readfirstlane_b32 s45, v5
    s_cmp_ge_u32 s45, s44
    s_cbranch_scc1 L_pvgo
    s_sleep 1
    s_sub_u32 s60, s60, 1
    s_cbranch_scc0 L_pvwait
    s_branch L_end
L_pv_done:
    s_nop 4
    v_cndmask_b32 v112, v112, v116, s[56:57]
    v_cndmask_b32 v113, v113, v117, s[56:57]
    v_cndmask_b32 v114, v114, v118, s[56:57]
    v_cndmask_b32 v115, v115, v119, s[56:57]
    v_bfi_b32 v112, v15, s61, v112
    v_bfi_b32 v113, v15, s61, v113
    v_bfi_b32 v114, v15, s0, v114
    v_bfi_b32 v115, v15, s0, v115
    s_mov_b32 exec_lo, 0x000f000f
    s_mov_b32 exec_hi, 0x000f000f
    buffer_store_dwordx4 v[112:115], v160, s[36:39], s51 offen
    s_cmp_lg_u32 s15, 0
    s_cbranch_scc1 L_far28
L_pub29:
    s_mov_b64 exec, -1
    s_cmp_eq_u32 s33, 7
    s_cbranch_scc1 L_last
    s_barrier
    buffer_load_dwordx4 v[24:27], v162, s[36:39], s52 offen sc1
    buffer_load_dwordx4 v[28:31], v162, s[36:39], s59 offen sc1
    s_cmp_lg_u32 s15, 0
    s_cbranch_scc1 L_spoll0
    s_waitcnt vmcnt(3)
L_spoll:
    v_bitop3_b32 v5, v32, v34, s61 bitop3:0x7e
    v_bitop3_b32 v7, v33, v35, s0 bitop3:0x7e
    v_or_b32 v5, v5, v7
    v_cmp_ne_u32_sdwa vcc, v5, 0 src0_sel:BYTE_0 src1_sel:DWORD
    s_cmp_eq_u64 vcc, 0
    s_cbranch_scc1 L_sok
    s_xor_b32 s54, s54, s15
    buffer_load_dwordx2 v[32:33], v161, s[36:39], s54 offen sc1
    buffer_load_dwordx2 v[34:35], v161, s[36:39], s54 offen offset:256 sc1
    s_waitcnt vmcnt(0)
    s_sub_u32 s60, s60, 1
    s_cbranch_scc0 L_spoll
    s_branch L_end
L_oagain:
    s_xor_b32 s52, s52, s15
    s_xor_b32 s59, s59, s15
    buffer_load_dwordx4 v[24:27], v162, s[36:39], s52 offen sc1
    buffer_load_dwordx4 v[28:31], v162, s[36:39], s59 offen sc1
    s_sub_u32 s60, s60, 1
    s_cbranch_scc0 L_opoll
    s_branch L_end
L_sok:
    v_and_b32 v32, s63, v32
    v_and_b32 v34, s63, v34
    v_and_b32 v33, s1, v33
    v_and_b32 v35, s1, v35
    v_max_f32 v36, v32, v34
    v_mov_b32 v37, v36
    s_nop 1
    v_permlane16_swap_b32 v36, v37
    v_max_f32 v36, v36, v37
    v_mov_b32 v37, v36
    s_nop 1
    v_permlane32_swap_b32 v36, v37
    v_max_f32 v36, v36, v37
    v_sub_f32 v32, v32, v36
    v_sub_f32 v34, v34, v36
    v_mul_f32 v32, s46, v32
    v_mul_f32 v34, s46, v34
    v_exp_f32 v32, v32
    v_exp_f32 v34, v34
    s_nop 0
    v_mul_f32 v36, v33, v32
    v_fmac_f32 v36, v35, v34
    v_mov_b32 v37, v36
    s_nop 1
    v_permlane16_swap_b32 v36, v37
    v_add_f32 v36, v36, v37
    v_mov_b32 v37, v36
    s_nop 1
    v_permlane32_swap_b32 v36, v37
    v_add_f32 v36, v36, v37
    v_rcp_f32 v36, v36
    s_nop 0
    v_mul_f32 v32, v32, v36
    v_mul_f32 v34, v34, v36
    s_cmp_ge_u32 s3, 4
    s_barrier
    s_cbranch_scc1 L_opoll
    ds_read_b64_tr_b16 v[48:49], v164 offset:0
    ds_read_b64_tr_b16 v[50:51], v164 offset:2048
    ds_read_b64_tr_b16 v[52:53], v164 offset:4096
    ds_read_b64_tr_b16 v[54:55], v164 offset:6144
    ds_read_b64_tr_b16 v[56:57], v164 offset:8192
    ds_read_b64_tr_b16 v[58:59], v164 offset:10240
    ds_read_b64_tr_b16 v[60:61], v164 offset:12288
    ds_read_b64_tr_b16 v[62:63], v164 offset:14336
    ds_read_b64_tr_b16 v[64:65], v164 offset:16384
    ds_read_b64_tr_b16 v[66:67], v164 offset:18432
    ds_read_b64_tr_b16 v[68:69], v164 offset:20480
    ds_read_b64_tr_b16 v[70:71], v164 offset:22528
    ds_read_b64_tr_b16 v[72:73], v164 offset:24576
    ds_read_b64_tr_b16 v[74:75], v164 offset:26624
    ds_read_b64_tr_b16 v[76:77], v164 offset:28672
    ds_read_b64_tr_b16 v[78:79], v164 offset:30720
L_opoll:
    s_waitcnt vmcnt(0)
    v_bitop3_b32 v5, v24, v25, s61 bitop3:0x7e
    v_bitop3_b32 v7, v26, v27, s0 bitop3:0x7e
    v_bitop3_b32 v8, v28, v29, s61 bitop3:0x7e
    v_bitop3_b32 v9, v30, v31, s0 bitop3:0x7e
    v_or3_b32 v5, v5, v9, v8
    v_or_b32 v5, v5, v7
    v_cmp_ne_u32_sdwa vcc, v5, 0 src0_sel:BYTE_0 src1_sel:DWORD
    v_and_b32 v24, s1, v24
    v_and_b32 v25, s1, v25
    v_and_b32 v26, s1, v26
    v_and_b32 v27, s1, v27
    s_cmp_lg_u64 vcc, 0
    s_cbranch_scc1 L_oagain
    v_and_b32 v28, s1, v28
    v_and_b32 v29, s1, v29
    v_and_b32 v30, s1, v30
    v_and_b32 v31, s1, v31
    v_pk_mul_f32 v[24:25], v[24:25], v[32:33] op_sel_hi:[1,0]
    v_pk_mul_f32 v[26:27], v[26:27], v[32:33] op_sel_hi:[1,0]
    v_pk_fma_f32 v[24:25], v[28:29], v[34:35], v[24:25] op_sel_hi:[1,0,1]
    v_pk_fma_f32 v[26:27], v[30:31], v[34:35], v[26:27] op_sel_hi:[1,0,1]
    s_nop 0
    v_permlane16_swap_b32 v24, v25
    v_permlane16_swap_b32 v26, v27
    v_add_f32 v24, v24, v25
    v_add_f32 v26, v26, v27
    s_nop 1
    v_permlane32_swap_b32 v24, v26
    v_add_f32 v24, v24, v26
    v_cvt_pk_bf16_f32 v24, v24, v24
    ds_write_b16 v165, v24 offset:6656
    s_cmp_ge_u32 s3, 4
    s_waitcnt lgkmcnt(0)
    s_barrier
    s_cbranch_scc1 L_exit
    ds_read_b128 v[16:19], v166 offset:5376
    ds_read_b128 v[20:23], v166 offset:5440
    ds_read_b128 v[24:27], v166 offset:5504
    ds_read_b128 v[28:31], v166 offset:5568
    ds_read_b128 v[32:35], v166 offset:5632
    ds_read_b128 v[36:39], v166 offset:5696
    ds_read_b128 v[40:43], v166 offset:5760
    ds_read_b128 v[44:47], v166 offset:5824
    s_waitcnt lgkmcnt(7)
    v_mfma_f32_16x16x32_bf16 v[112:115], v[48:51], v[16:19], 0
    s_waitcnt lgkmcnt(6)
    v_mfma_f32_16x16x32_bf16 v[112:115], v[52:55], v[20:23], v[112:115]
    s_waitcnt lgkmcnt(5)
    v_mfma_f32_16x16x32_bf16 v[112:115], v[56:59], v[24:27], v[112:115]
    s_waitcnt lgkmcnt(4)
    v_mfma_f32_16x16x32_bf16 v[112:115], v[60:63], v[28:31], v[112:115]
    s_waitcnt lgkmcnt(3)
    v_mfma_f32_16x16x32_bf16 v[112:115], v[64:67], v[32:35], v[112:115]
    s_waitcnt lgkmcnt(2)
    v_mfma_f32_16x16x32_bf16 v[112:115], v[68:71], v[36:39], v[112:115]
    s_waitcnt lgkmcnt(1)
    v_mfma_f32_16x16x32_bf16 v[112:115], v[72:75], v[40:43], v[112:115]
    s_waitcnt lgkmcnt(0)
    v_mfma_f32_16x16x32_bf16 v[112:115], v[76:79], v[44:47], v[112:115]
    s_mov_b32 exec_lo, 0x00030003
    s_mov_b32 exec_hi, 0x00030003
    s_nop 5
    v_bfi_b32 v112, v15, s61, v112
    v_bfi_b32 v113, v15, s61, v113
    v_bfi_b32 v114, v15, s0, v114
    v_bfi_b32 v115, v15, s0, v115
    buffer_store_dwordx4 v[112:115], v14, s[36:39], s53 offen sc1
    s_mov_b64 exec, -1
    s_branch L_exit
L_last:
    s_cmp_lg_u32 s3, 0
    s_cbranch_scc1 L_nofwd
L_fpoll:
    s_waitcnt vmcnt(0)
    v_bitop3_b32 v5, v32, v33, s61 bitop3:0x7e
    v_bitop3_b32 v7, v34, v35, s61 bitop3:0x7e
    v_or_b32 v5, v5, v7
    v_cmp_ne_u32_sdwa vcc, v5, 0 src0_sel:WORD_0 src1_sel:DWORD
    s_cmp_eq_u64 vcc, 0
    s_cbranch_scc1 L_fok
    s_xor_b32 s54, s54, s15
    s_mov_b32 exec_hi, 0xffff
    buffer_load_dwordx4 v[32:35], v6, s[36:39], s54 offen sc1
    s_mov_b32 exec_hi, -1
    s_sleep 1
    s_sub_u32 s60, s60, 1
    s_cbranch_scc0 L_fpoll
    s_branch L_end
L_fok:
    s_add_u32 s54, s55, 131072
    s_mov_b32 exec_hi, 0xffff
    buffer_store_dwordx4 v[32:35], v6, s[36:39], s54 offen sc1
    s_mov_b32 exec_hi, -1
L_nofwd:
    s_cmp_lg_u32 s62, 0
    s_cbranch_scc1 L_exit
    s_xor_b32 s40, s3, s30
    s_or_b32 s40, s40, s15
    s_cselect_b32 s55, 131072, s27
    s_mul_i32 s40, s3, 3072
    s_add_u32 s55, s55, s40
    s_add_u32 s40, s40, 114688
    v_add_u32 v13, s40, v6
    v_mov_b32 v148, s61
    v_mov_b32 v149, s61
    v_mov_b32 v150, s61
    v_mov_b32 v151, s61
    buffer_load_dwordx4 v[140:143], v6, s[36:39], s55 offen offset:0 sc1
    buffer_load_dwordx4 v[144:147], v6, s[36:39], s55 offen offset:1024 sc1
    s_mov_b32 exec_lo, 0xffffffff
    s_mov_b32 exec_hi, 0xffffffff
    buffer_load_dwordx4 v[148:151], v6, s[36:39], s55 offen offset:2048 sc1
    s_mov_b64 exec, -1
    s_mul_i32 s48, s32, 28672
    s_lshl_b32 s40, s3, 8
    s_add_u32 s48, s48, s40
    s_add_u32 s48, s48, 1048576
    s_add_u32 s49, s48, 7168
    s_add_u32 s50, s48, 14336
    s_add_u32 s51, s48, 21504
    v_mul_u32_u24 v12, 1792, v2
    v_lshl_add_u32 v12, v3, 4, v12
L_tpoll:
    s_waitcnt vmcnt(0)
    v_bitop3_b32 v5, v140, v141, s61 bitop3:0x7e
    v_bitop3_b32 v7, v142, v143, s61 bitop3:0x7e
    v_bitop3_b32 v8, v144, v145, s61 bitop3:0x7e
    v_bitop3_b32 v9, v146, v147, s61 bitop3:0x7e
    v_bitop3_b32 v10, v148, v149, s61 bitop3:0x7e
    v_bitop3_b32 v11, v150, v151, s61 bitop3:0x7e
    v_or3_b32 v5, v5, v11, v10
    v_or3_b32 v5, v5, v9, v8
    v_or_b32 v5, v5, v7
    v_cmp_ne_u32_sdwa vcc, v5, 0 src0_sel:WORD_0 src1_sel:DWORD
    s_cmp_eq_u64 vcc, 0
    s_cbranch_scc1 L_tok
    s_sleep 8
    buffer_load_dwordx4 v[140:143], v6, s[36:39], s55 offen offset:0 sc1
    buffer_load_dwordx4 v[144:147], v6, s[36:39], s55 offen offset:1024 sc1
    s_mov_b32 exec_lo, 0xffffffff
    s_mov_b32 exec_hi, 0xffffffff
    buffer_load_dwordx4 v[148:151], v6, s[36:39], s55 offen offset:2048 sc1
    s_mov_b64 exec, -1
    s_sub_u32 s60, s60, 1
    s_cbranch_scc0 L_tpoll
    s_branch L_end
L_tok:
    s_mov_b32 s47, 3072
L_w30:
    ds_read_b32 v5, v1 offset:9060
    s_waitcnt lgkmcnt(0)
    v_readfirstlane_b32 s45, v5
    s_cmp_ge_u32 s45, 8
    s_cbranch_scc1 L_d31
    s_sleep 1
    s_sub_u32 s60, s60, 1
    s_cbranch_scc0 L_w30
    s_branch L_end
L_d31:
    ds_write_b128 v13, v[140:143] offset:0
    ds_write_b128 v13, v[144:147] offset:1024
    s_mov_b32 exec_lo, 0xffffffff
    s_mov_b32 exec_hi, 0xffffffff
    ds_write_b128 v13, v[148:151] offset:2048
    s_mov_b64 exec, -1
    s_cmp_eq_u32 s3, 7
    s_cbranch_scc0 L_hget
    s_waitcnt lgkmcnt(0)
    s_barrier
    s_cmp_lg_u32 s32, 0
    s_cbranch_scc1 L_exit
    v_mov_b32 v5, s61
    s_mov_b64 exec, 1
    buffer_store_dword v5, v6, s[36:39], 0 offen
    s_mov_b64 exec, -1
    s_branch L_exit
L_hget:
    v_lshl_add_u32 v13, v136, 2, v1
    v_lshl_add_u32 v14, v0, 5, v1
    s_mul_i32 s40, s3, 448
    v_lshl_add_u32 v40, v0, 3, s40
    v_add_u32 v40, v40, v1
    s_lshl2_add_u32 s41, s32, s3
    s_mul_i32 s41, s41, 224
    v_lshl_add_u32 v41, v0, 2, s41
    v_lshlrev_b32 v137, 16, v138
    v_mov_b32 v42, 0x3b124925
    s_mov_b32 s52, 114688
    s_mov_b32 s53, 0x7060302
    v_mov_b32 v48, 0
    v_mov_b32 v49, 0
    v_mov_b32 v50, 0
    v_mov_b32 v51, 0
    v_mov_b32 v52, 0
    v_mov_b32 v53, 0
    v_mov_b32 v54, 0
    v_mov_b32 v55, 0
    s_branch L_hpoll
L_hagain:
    s_sub_u32 s60, s60, 1
    s_cbranch_scc1 L_end
L_hpoll:
    buffer_load_dwordx4 v[16:19], v12, s[36:39], s48 offen sc1
    buffer_load_dwordx4 v[20:23], v12, s[36:39], s49 offen sc1
    buffer_load_dwordx4 v[24:27], v12, s[36:39], s50 offen sc1
    buffer_load_dwordx4 v[28:31], v12, s[36:39], s51 offen sc1
    s_waitcnt vmcnt(0)
    v_bitop3_b32 v5, v16, v17, s61 bitop3:0x7e
    v_bitop3_b32 v7, v18, v19, s0 bitop3:0x7e
    v_bitop3_b32 v8, v20, v21, s61 bitop3:0x7e
    v_bitop3_b32 v9, v22, v23, s0 bitop3:0x7e
    v_bitop3_b32 v10, v24, v25, s61 bitop3:0x7e
    v_bitop3_b32 v11, v26, v27, s0 bitop3:0x7e
    v_bitop3_b32 v56, v28, v29, s61 bitop3:0x7e
    v_bitop3_b32 v57, v30, v31, s0 bitop3:0x7e
    v_or3_b32 v5, v5, v57, v56
    v_or3_b32 v5, v5, v11, v10
    v_or3_b32 v5, v5, v9, v8
    v_or_b32 v5, v5, v7
    v_cmp_ne_u32_sdwa vcc, v5, 0 src0_sel:BYTE_0 src1_sel:DWORD
    v_and_b32 v16, s1, v16
    v_and_b32 v17, s1, v17
    v_and_b32 v18, s1, v18
    v_and_b32 v19, s1, v19
    s_cmp_lg_u64 vcc, 0
    s_cbranch_scc1 L_hagain
    v_and_b32 v20, s1, v20
    v_and_b32 v21, s1, v21
    v_and_b32 v22, s1, v22
    v_and_b32 v23, s1, v23
    v_and_b32 v24, s1, v24
    v_and_b32 v25, s1, v25
    v_and_b32 v26, s1, v26
    v_and_b32 v27, s1, v27
    v_and_b32 v28, s1, v28
    v_and_b32 v29, s1, v29
    v_and_b32 v30, s1, v30
    v_and_b32 v31, s1, v31
    v_pk_add_f32 v[16:17], v[16:17], v[20:21]
    v_pk_add_f32 v[18:19], v[18:19], v[22:23]
    v_pk_add_f32 v[24:25], v[24:25], v[28:29]
    v_pk_add_f32 v[26:27], v[26:27], v[30:31]
    v_pk_add_f32 v[32:33], v[16:17], v[24:25]
    v_pk_add_f32 v[34:35], v[18:19], v[26:27]
    s_nop 0
    v_permlane16_swap_b32 v32, v33
    v_permlane16_swap_b32 v34, v35
    v_add_f32 v32, v32, v33
    v_add_f32 v34, v34, v35
    s_nop 1
    v_permlane32_swap_b32 v32, v34
    v_add_f32 v32, v32, v34
    v_cvt_pk_bf16_f32 v32, 0, v32
    v_add_f32 v32, v32, v137
    v_cvt_pk_bf16_f32 v32, 0, v32
    ds_write_b32 v13, v32 offset:9216
    s_cmp_ge_u32 s3, 4
    s_waitcnt lgkmcnt(0)
    s_barrier
    s_cbranch_scc1 L_exit
L_hdry:
    s_mov_b32 exec_hi, 0x00ffffff
    ds_read_b128 v[48:51], v14 offset:9216
    ds_read_b128 v[52:55], v14 offset:9232
    ds_read_b64 v[138:139], v40 offset:9216
    s_mov_b32 exec_hi, -1
    s_waitcnt lgkmcnt(1)
    v_pk_add_f32 v[20:21], v[48:49], v[50:51]
    v_pk_mul_f32 v[24:25], v[48:49], v[48:49]
    v_pk_add_f32 v[22:23], v[52:53], v[54:55]
    v_pk_fma_f32 v[24:25], v[50:51], v[50:51], v[24:25]
    v_pk_add_f32 v[20:21], v[20:21], v[22:23]
    v_pk_fma_f32 v[24:25], v[52:53], v[52:53], v[24:25]
    v_add_f32 v20, v20, v21
    v_pk_fma_f32 v[24:25], v[54:55], v[54:55], v[24:25]
    v_add_f32 v24, v24, v25
    s_nop 0
    v_add_f32_dpp v20, v20, v20 quad_perm:[1,0,3,2] row_mask:0xf bank_mask:0xf
    v_add_f32_dpp v24, v24, v24 quad_perm:[1,0,3,2] row_mask:0xf bank_mask:0xf
    s_nop 0
    v_add_f32_dpp v20, v20, v20 quad_perm:[2,3,0,1] row_mask:0xf bank_mask:0xf
    v_add_f32_dpp v24, v24, v24 quad_perm:[2,3,0,1] row_mask:0xf bank_mask:0xf
    s_nop 0
    v_add_f32_dpp v20, v20, v20 row_half_mirror row_mask:0xf bank_mask:0xf
    v_add_f32_dpp v24, v24, v24 row_half_mirror row_mask:0xf bank_mask:0xf
    s_nop 0
    v_add_f32_dpp v20, v20, v20 row_mirror row_mask:0xf bank_mask:0xf
    v_add_f32_dpp v24, v24, v24 row_mirror row_mask:0xf bank_mask:0xf
    s_nop 0
    v_add_f32_dpp v20, v20, v20 row_bcast:15 row_mask:0xa bank_mask:0xf
    v_add_f32_dpp v24, v24, v24 row_bcast:15 row_mask:0xa bank_mask:0xf
    s_nop 0
    v_add_f32_dpp v20, v20, v20 row_bcast:31 row_mask:0xc bank_mask:0xf
    v_add_f32_dpp v24, v24, v24 row_bcast:31 row_mask:0xc bank_mask:0xf
    v_readlane_b32 s40, v20, 63
    v_readlane_b32 s41, v24, 63
    s_nop 1
    v_mul_f32 v26, s41, v42
    v_mul_f32 v27, s40, v42
    v_fma_f32 v26, -v27, v27, v26
    v_cvt_pk_bf16_f32 v22, 0, v27
    v_cvt_pk_bf16_f32 v23, 0, abs(v26)
    v_sub_f32 v24, v27, v22
    v_add_f32 v23, 0x3727c5ac, v23
    v_cvt_pk_bf16_f32 v23, 0, v23
    v_sqrt_f32 v23, v23
    s_waitcnt lgkmcnt(0)
    v_pk_add_f32 v[36:37], v[138:139], v[22:23] op_sel_hi:[1,0] neg_lo:[0,1] neg_hi:[0,1]
    v_cvt_pk_bf16_f32 v23, 0, v23
    v_rcp_f32 v23, v23
    v_cvt_pk_bf16_f32 v36, 0, v36
    v_mul_f32 v25, abs(v26), v23
    v_cvt_pk_bf16_f32 v37, 0, v37
    v_mul_f32 v25, v25, v23
    v_mul_f32 v24, v24, v23
    v_cvt_pk_bf16_f32 v25, 0, v25
    v_pk_mul_f32 v[36:37], v[36:37], v[22:23] op_sel:[0,1] op_sel_hi:[1,1]
    v_add_f32 v25, 0x3727c5ac, v25
    v_cvt_pk_bf16_f32 v24, 0, v24
    v_cvt_pk_bf16_f32 v25, 0, v25
    v_cvt_pk_bf16_f32 v36, 0, v36
    v_sqrt_f32 v25, v25
    v_cvt_pk_bf16_f32 v37, 0, v37
    v_cvt_pk_bf16_f32 v25, 0, v25
    v_pk_add_f32 v[36:37], v[36:37], v[24:25] op_sel_hi:[1,0] neg_lo:[0,1] neg_hi:[0,1]
    v_rcp_f32 v25, v25
    v_cvt_pk_bf16_f32 v36, 0, v36
    v_cvt_pk_bf16_f32 v37, 0, v37
    s_mov_b32 exec_hi, 0x00ffffff
    v_pk_mul_f32 v[36:37], v[36:37], v[24:25] op_sel:[0,1] op_sel_hi:[1,1]
    v_cvt_pk_bf16_f32 v36, 0, v36
    v_cvt_pk_bf16_f32 v37, 0, v37
    v_bfe_u32 v16, v36, 16, 15
    v_bfe_u32 v17, v37, 16, 15
    v_subrev_u32 v16, 13824, v16
    v_subrev_u32 v17, 13824, v17
    v_lshrrev_b32 v18, 31, v36
    v_lshrrev_b32 v19, 31, v37
    v_cmp_le_u32 vcc, 3072, v16
    v_cmp_le_u32 s[56:57], s47, v17
    v_mad_u32_u24 v16, v18, s47, v16
    v_mad_u32_u24 v17, v19, s47, v17
    v_cndmask_b32 v16, v16, 0, vcc
    v_cndmask_b32 v17, v17, 0, s[56:57]
    v_lshl_add_u32 v16, v16, 2, s52
    v_lshl_add_u32 v17, v17, 2, s52
    ds_read_b32 v38, v16
    ds_read_b32 v39, v17
    s_or_b64 s[58:59], vcc, s[56:57]
    s_waitcnt lgkmcnt(0)
    v_and_b32 v38, s63, v38
    v_and_b32 v39, s63, v39
    s_cbranch_scc1 L_direct
L_fin:
    v_pk_add_f32 v[38:39], v[38:39], v[138:139]
    v_cvt_pk_bf16_f32 v38, v38, v39
    global_store_dword v41, v38, s[24:25]
    s_mov_b32 exec_hi, -1
L_exit:
L_end:
    s_endpgm
L_pfend:
L_direct:
    s_mov_b32 exec_hi, -1
    s_mov_b64 s[54:55], vcc
    s_mov_b32 s58, 0
    v_mov_b32 v7, 0
    global_load_ushort v46, v7, s[22:23]
L_dpass:
    s_cmp_eq_u64 s[54:55], 0
    s_cbranch_scc1 L_dswap
    s_ff1_i32_b64 s52, s[54:55]
    s_bitset0_b64 s[54:55], s52
    s_nop 3
    v_readlane_b32 s50, v36, s52
    v_mov_b32 v80, 0
    v_lshlrev_b32 v5, 3, v0
    s_mov_b32 s53, 0
L_dloop:
    global_load_dwordx2 v[76:77], v5, s[16:17]
    global_load_dwordx2 v[78:79], v5, s[18:19]
    global_load_dwordx2 v[84:85], v5, s[20:21]
    v_add_u32 v5, 512, v5
    s_waitcnt vmcnt(0)
    v_lshlrev_b32 v48, 16, v76
    v_and_b32 v49, s63, v76
    v_lshlrev_b32 v50, 16, v77
    v_and_b32 v51, s63, v77
    v_lshlrev_b32 v52, 16, v78
    v_and_b32 v53, s63, v78
    v_lshlrev_b32 v54, 16, v79
    v_and_b32 v55, s63, v79
    v_lshlrev_b32 v56, 16, v84
    v_and_b32 v57, s63, v84
    v_lshlrev_b32 v58, 16, v85
    v_and_b32 v59, s63, v85
    v_mov_b32 v47, 0xbdd2d3e8
    v_fma_f32 v60, s50, v48, v52
    v_fma_f32 v61, s50, v49, v53
    v_fma_f32 v62, s50, v50, v54
    v_fma_f32 v63, s50, v51, v55
    v_mul_f32 v68, v60, v60
    v_mul_f32 v69, v61, v61
    v_mul_f32 v70, v62, v62
    v_mul_f32 v71, v63, v63
    v_fmaak_f32 v68, v68, v47, 0xc0135761
    v_fmaak_f32 v69, v69, v47, 0xc0135761
    v_fmaak_f32 v70, v70, v47, 0xc0135761
    v_fmaak_f32 v71, v71, v47, 0xc0135761
    v_mul_f32 v68, v68, v60
    v_mul_f32 v69, v69, v61
    v_mul_f32 v70, v70, v62
    v_mul_f32 v71, v71, v63
    v_exp_f32 v68, v68
    v_mul_f32 v60, v60, v56
    v_exp_f32 v69, v69
    v_mul_f32 v61, v61, v57
    v_exp_f32 v70, v70
    v_mul_f32 v62, v62, v58
    v_exp_f32 v71, v71
    v_mul_f32 v63, v63, v59
    v_add_f32 v68, 1.0, v68
    v_add_f32 v69, 1.0, v69
    v_add_f32 v70, 1.0, v70
    v_add_f32 v71, 1.0, v71
    v_rcp_f32 v68, v68
    v_rcp_f32 v69, v69
    v_rcp_f32 v70, v70
    v_rcp_f32 v71, v71
    s_nop 0
    v_fmac_f32 v80, v60, v68
    v_fmac_f32 v80, v61, v69
    v_fmac_f32 v80, v62, v70
    v_fmac_f32 v80, v63, v71
    s_add_u32 s53, s53, 1
    s_cmp_lt_u32 s53, 7
    s_cbranch_scc1 L_dloop
    s_nop 1
    v_add_f32_dpp v80, v80, v80 quad_perm:[1,0,3,2] row_mask:0xf bank_mask:0xf
    s_nop 1
    v_add_f32_dpp v80, v80, v80 quad_perm:[2,3,0,1] row_mask:0xf bank_mask:0xf
    s_nop 1
    v_add_f32_dpp v80, v80, v80 row_half_mirror row_mask:0xf bank_mask:0xf
    s_nop 1
    v_add_f32_dpp v80, v80, v80 row_mirror row_mask:0xf bank_mask:0xf
    s_nop 1
    v_add_f32_dpp v80, v80, v80 row_bcast:15 row_mask:0xa bank_mask:0xf
    s_nop 1
    v_add_f32_dpp v80, v80, v80 row_bcast:31 row_mask:0xc bank_mask:0xf
    s_nop 1
    v_readlane_b32 s40, v80, 63
    s_nop 1
    v_mov_b32 v80, s40
    v_cvt_pk_bf16_f32 v80, 0, v80
    v_lshlrev_b32 v81, 16, v46
    v_add_f32 v80, v80, v81
    v_cvt_pk_bf16_f32 v80, 0, v80
    v_cmp_eq_u32 vcc, s52, v0
    s_nop 1
    v_cndmask_b32 v38, v38, v80, vcc
    s_branch L_dpass
L_dswap:
    v_swap_b32 v36, v37
    v_swap_b32 v38, v39
    s_mov_b64 s[54:55], s[56:57]
    s_add_u32 s58, s58, 1
    s_cmp_eq_u32 s58, 1
    s_cbranch_scc1 L_dpass
    s_mov_b32 exec_hi, 0x00ffffff
    s_branch L_fin
L_idfar:
    buffer_store_dwordx4 v[112:115], v14, s[36:39], s58 offen sc1
    v_mov_b32 v17, 2097153
    s_branch L_idloc
L_far22:
    s_add_u32 s45, s40, 2097152
    buffer_store_dwordx4 v[124:127], v6, s[36:39], s45 offen sc1
    s_branch L_pub23
L_far26:
    s_add_u32 s45, s40, 2097152
    buffer_store_dword v16, v8, s[36:39], s45 offen sc1
    s_branch L_pub27
L_far28:
    s_add_u32 s45, s51, 2097152
    buffer_store_dwordx4 v[112:115], v160, s[36:39], s45 offen sc1
    s_branch L_pub29
L_spoll0:
    s_waitcnt vmcnt(0)
    s_branch L_spoll
L_codeend:
.if L_codeend - L_pc0 < 9216
.error "code prefetch would run past the code"
.endif
.section .rodata,"a"
.p2align 6
.amdhsa_kernel sequential_preLN__sliding_block_cached__mixer_token_mlp__decode_kernel
  .amdhsa_next_free_vgpr 168
  .amdhsa_next_free_sgpr 96
  .amdhsa_accum_offset 168
  .amdhsa_float_denorm_mode_32 3
  .amdhsa_group_segment_fixed_size 0
  .amdhsa_kernarg_size 104
  .amdhsa_user_sgpr_count 2
  .amdhsa_user_sgpr_kernarg_segment_ptr 1
  .amdhsa_system_sgpr_workgroup_id_x 1
.end_amdhsa_kernel
```
